```python
import torch

def _softmax(x, axis=-1):
    return torch.softmax(x, dim=axis)
def _gelu(x):
    return torch.nn.functional.gelu(x, approximate="tanh")
def _silu(x):
    return torch.nn.functional.silu(x)
def _sigmoid(x):
    return torch.sigmoid(x)
def _layernorm(x, axis=-1, eps=1e-5):
    m = x.mean(dim=axis, keepdim=True)
    v = x.var(dim=axis, keepdim=True, unbiased=False)
    return (x - m) / torch.sqrt(v + eps)
def _scatter_add(tgt, idx, src, axis=0):
    return tgt.clone().index_add_(axis, idx, src)
def _segment_sum(src, seg, n):
    out = torch.zeros((n,) + src.shape[1:], dtype=src.dtype)
    return out.index_add_(0, seg, src)
def _pad(x, pw):
    flat = tuple(v for pair in reversed(pw) for v in pair)
    return torch.nn.functional.pad(x, flat)

kernel_name = 'recurrent_scan__mha_block__swiglu_ffn__prompt'

def setup_inputs():

    _w = (lambda a: (lambda t: t.to(torch.bfloat16) if t.is_floating_point() else t)(torch.as_tensor(a)))
    def _A_setup():
        B, S, D, H = 1, 2048, 512, 32
        return {
            "x": _w((lambda *s: torch.randn(*s, dtype=torch.bfloat16) * 0.05)(B, S, D)),
            "wqkv": _w((lambda *s: torch.randn(*s, dtype=torch.bfloat16) * 0.05)(D, 3 * D)),
            "wo": _w((lambda *s: torch.randn(*s, dtype=torch.bfloat16) * 0.05)(D, D)),
        }
    _A_in = _A_setup()

    def _B_setup():
        B, S, D, F = 1, 2048, 512, 1376
        return {
            "x": _w((lambda *s: torch.randn(*s, dtype=torch.bfloat16) * 0.05)(B, S, D)),
            "w_gate": _w((lambda *s: torch.randn(*s, dtype=torch.bfloat16) * 0.05)(D, F)),
            "w_up": _w((lambda *s: torch.randn(*s, dtype=torch.bfloat16) * 0.05)(D, F)),
            "w_down": _w((lambda *s: torch.randn(*s, dtype=torch.bfloat16) * 0.05)(F, D)),
        }
    _B_in = _B_setup()

    return {
        "A_x": _A_in["x"],
        "A_wqkv": _A_in["wqkv"],
        "A_wo": _A_in["wo"],
        "B_x": _B_in["x"],
        "B_w_gate": _B_in["w_gate"],
        "B_w_up": _B_in["w_up"],
        "B_w_down": _B_in["w_down"],
    }

def reference(A_x, A_wqkv, A_wo, B_x, B_w_gate, B_w_up, B_w_down):
    def _A_ref(x, wqkv, wo):
        B, S, D = x.shape
        H = 32
        Dh = D // H
        qkv = (lambda x, *d: x.permute(*d))((x @ wqkv).reshape(B, S, 3, H, Dh), 2, 0, 3, 1, 4)
        q, k, v = qkv[0], qkv[1], qkv[2]
        scores = torch.einsum("bhqd,bhkd->bhqk", q, k) * (Dh ** -0.5)
        p = _softmax(scores, axis=-1)
        o = torch.einsum("bhqk,bhkd->bhqd", p, v)
        return (lambda x, *d: x.permute(*d))(o, 0, 2, 1, 3).reshape(B, S, D) @ wo

    def _B_ref(x, w_gate, w_up, w_down):
        g = _silu(x @ w_gate)
        u = x @ w_up
        return (g * u) @ w_down

    x = A_x
    xn = _layernorm(x, axis=-1)
    s = _A_ref(xn, A_wqkv, A_wo)
    g = _silu(_B_ref(xn, B_w_gate, B_w_up, B_w_down))
    return x + s * g
```

```asm
; @launch grid=(256,1,1) block=(512,1,1) lds=163840
.amdgcn_target "amdgcn-amd-amdhsa--gfx950"
.text
.globl recurrent_scan__mha_block__swiglu_ffn__prompt_kernel
.p2align 8
.type recurrent_scan__mha_block__swiglu_ffn__prompt_kernel,@function
recurrent_scan__mha_block__swiglu_ffn__prompt_kernel:
    s_cmp_ge_u32 s2, 256
    s_cbranch_scc1 L_end
    s_getpc_b64 s[4:5]
L_pc_1:
    s_lshr_b32 s48, s2, 3
    s_mul_i32 s48, s48, 10
    v_min_u32 v30, 9, v0
    v_add_lshl_u32 v30, v30, s48, 7
    v_min_u32 v30, L_end-L_pc_1-4, v30
    global_load_dword v255, v30, s[4:5]
    s_load_dwordx16 s[64:79], s[0:1], 0
    s_load_dwordx4 s[80:83], s[0:1], 64
    v_lshrrev_b32 v1, 6, v0
    s_and_b32 s40, s2, 7
    s_lshr_b32 s41, s2, 3
    v_readfirstlane_b32 s36, v1
    v_and_b32 v1, 63, v0
    s_and_b32 s48, s40, 1
    s_lshl_b32 s48, s48, 3
    s_and_b32 s49, s41, 7
    s_add_u32 s42, s48, s49
    s_lshr_b32 s48, s40, 1
    s_lshl_b32 s48, s48, 2
    s_lshr_b32 s49, s41, 3
    s_add_u32 s43, s48, s49
    s_lshl_b32 s92, s36, 11
    s_lshl_b32 s93, s36, 10
    s_lshl_b32 s94, s36, 9
    v_lshrrev_b32 v26, 3, v1
    v_lshrrev_b32 v27, 4, v1
    v_and_b32 v28, 7, v1
    v_xor_b32 v29, v28, v27
    v_lshlrev_b32 v29, 4, v29
    s_lshl_b32 s48, s42, 7
    s_lshl_b32 s49, s36, 4
    s_add_u32 s48, s48, s49
    v_add_u32 v2, s48, v26
    v_lshl_add_u32 v2, v2, 10, v29
    v_xor_b32 v3, 64, v2
    v_add_u32 v3, 0x1c00, v3
    s_lshr_b32 s50, s43, 1
    s_and_b32 s55, s43, 1
    s_lshl_b32 s48, s55, 10
    s_lshl_b32 s49, s50, 7
    s_add_u32 s52, s48, s49
    s_lshl_b32 s48, s55, 6
    s_add_u32 s53, s48, s49
    s_add_u32 s53, s53, 2048
    s_lshl_b32 s51, s36, 3
    s_and_b32 s48, s36, 1
    s_lshl_b32 s49, s48, 2
    s_lshl_b32 s48, s48, 1
    v_and_b32 v27, 1, v27
    v_lshlrev_b32 v27, 1, v27
    v_xor_b32 v27, v27, v28
    v_xor_b32 v27, s49, v27
    v_lshlrev_b32 v27, 4, v27
    v_add_u32 v4, s51, v26
    v_mul_u32_u24 v4, 3072, v4
    v_add3_u32 v4, v4, v27, s52
    v_bfe_u32 v5, v1, 2, 3
    v_add_u32 v5, s51, v5
    v_mul_u32_u24 v5, 3072, v5
    v_and_b32 v27, 3, v1
    v_xor_b32 v27, s48, v27
    v_lshlrev_b32 v27, 4, v27
    v_add3_u32 v5, v5, v27, s53
    s_lshr_b32 s48, s41, 3
    s_lshl_b32 s48, s48, 0
    s_add_u32 s48, s48, s41
    s_and_b32 s48, s48, 3
    s_lshl_b32 s48, s48, 1
    s_add_u32 s54, s48, s40
    s_waitcnt lgkmcnt(0)
    s_mov_b32 s8, s64
    s_and_b32 s9, s65, 0xffff
    s_mov_b32 s10, 0x200000
    s_mov_b32 s11, 0x00020000
    s_mov_b32 s12, s66
    s_and_b32 s13, s67, 0xffff
    s_mov_b32 s14, 0x180000
    s_mov_b32 s15, 0x00020000
    s_add_u32 s53, s54, 0
    s_and_b32 s53, s53, 7
    s_add_u32 m0, s92, 0
    s_mul_i32 s7, s53, 128
    buffer_load_dwordx4 v2, s[8:11], s7 offen offset:0 lds
    buffer_load_dwordx4 v3, s[8:11], s7 offen offset:1024 lds
    s_add_u32 m0, s93, 16384
    s_mul_i32 s7, s53, 196608
    buffer_load_dwordx4 v4, s[12:15], s7 offen offset:0 lds
    s_add_u32 m0, s94, 24576
    s_mov_b32 exec_hi, 0
    buffer_load_dwordx4 v5, s[12:15], s7 offen offset:0 lds
    s_mov_b32 exec_hi, -1
    s_add_u32 s4, s82, 15138816
    s_addc_u32 s5, s83, 0
    s_load_dword s3, s[4:5], 0
    s_and_b32 s37, s36, 3
    s_lshr_b32 s38, s36, 2
    s_mov_b32 s39, 0x3f803f80
    s_lshr_b32 s50, s37, 1
    s_and_b32 s51, s37, 1
    s_xor_b32 s48, s50, 0
    s_xor_b32 s49, s51, 0
    s_mul_i32 s49, s49, 12288
    s_mul_i32 s88, s48, 6144
    s_add_u32 s88, s88, s49
    s_lshl_b32 s44, s48, 12
    s_lshl_b32 s84, s48, 11
    s_xor_b32 s48, s50, 0
    s_xor_b32 s49, s51, 1
    s_mul_i32 s49, s49, 12288
    s_mul_i32 s89, s48, 6144
    s_add_u32 s89, s89, s49
    s_xor_b32 s48, s50, 1
    s_xor_b32 s49, s51, 0
    s_mul_i32 s49, s49, 12288
    s_mul_i32 s90, s48, 6144
    s_add_u32 s90, s90, s49
    s_lshl_b32 s45, s48, 12
    s_lshl_b32 s85, s48, 11
    s_xor_b32 s48, s50, 1
    s_xor_b32 s49, s51, 1
    s_mul_i32 s49, s49, 12288
    s_mul_i32 s91, s48, 6144
    s_add_u32 s91, s91, s49
    v_and_b32 v26, 15, v1
    v_lshrrev_b32 v27, 4, v1
    v_bfe_u32 v28, v1, 1, 3
    v_xor_b32 v28, v28, v27
    s_lshl_b32 s48, s50, 2
    v_xor_b32 v28, s48, v28
    v_lshlrev_b32 v28, 4, v28
    s_lshl_b32 s48, s37, 12
    s_lshl_b32 s49, s55, 11
    s_add_u32 s48, s48, s49
    v_lshlrev_b32 v26, 7, v26
    v_add3_u32 v9, v26, v28, s48
    v_xor_b32 v10, 0x800, v9
    v_xor_b32 v11, 64, v9
    v_xor_b32 v12, 64, v10
    v_bfe_u32 v26, v1, 2, 2
    v_lshl_add_u32 v26, v27, 3, v26
    v_and_b32 v27, 1, v27
    v_and_b32 v29, 3, v1
    v_lshlrev_b32 v29, 3, v29
    v_bfe_u32 v30, v1, 3, 1
    v_lshl_add_u32 v30, v27, 1, v30
    s_lshl_b32 s48, s51, 1
    v_xor_b32 v30, s48, v30
    v_lshl_add_u32 v30, v30, 5, v29
    v_lshl_add_u32 v13, v26, 7, v30
    v_add_u32 v13, 0x4000, v13
    v_xor_b32 v14, 64, v13
    v_xor_b32 v30, s51, v27
    v_lshl_add_u32 v30, v30, 5, v29
    v_lshl_add_u32 v30, v26, 6, v30
    v_add_u32 v30, 0x6000, v30
    v_xor_b32 v31, 32, v30
    s_cmp_eq_u32 s38, 0
    s_cselect_b64 vcc, -1, 0
    v_cndmask_b32 v13, v30, v13, vcc
    v_cndmask_b32 v14, v31, v14, vcc
    v_mul_u32_u24 v30, 192, v26
    v_add_u32 v30, v30, v29
    v_lshlrev_b32 v27, 5, v27
    v_add_u32 v15, v30, v27
    v_sub_u32 v21, v30, v27
    v_and_b32 v26, 3, v1
    v_cmp_eq_u32 vcc, 0, v26
    v_mov_b32 v27, s39
    s_nop 0
    v_cndmask_b32 v116, 0, v27, vcc
    v_cndmask_b32 v117, 0, v27, vcc
    v_cndmask_b32 v118, 0, v27, vcc
    v_cndmask_b32 v119, 0, v27, vcc
    s_mov_b32 s20, s82
    s_and_b32 s21, s83, 0xffff
    s_mov_b32 s22, 0x1000000
    s_mov_b32 s23, 0x00020000
    s_mov_b32 s24, s76
    s_and_b32 s25, s77, 0xffff
    s_mov_b32 s26, 0x158000
    s_mov_b32 s27, 0x00020000
    s_mov_b32 s28, s68
    s_and_b32 s29, s69, 0xffff
    s_mov_b32 s30, 0x80000
    s_mov_b32 s31, 0x00020000
    s_mov_b32 s32, s78
    s_and_b32 s33, s79, 0xffff
    s_mov_b32 s34, 0x200000
    s_mov_b32 s35, 0x00020000
    s_cmp_eq_u32 s38, 0
    s_cselect_b32 s16, s72, s74
    s_cselect_b32 s17, s73, s75
    s_and_b32 s17, s17, 0xffff
    s_mov_b32 s18, 0x158000
    s_mov_b32 s19, 0x00020000
    s_mul_i32 s95, s38, 12288
    s_mul_i32 s50, s37, 3072
    s_add_u32 s95, s95, s50
    s_lshr_b32 s52, s43, 1
    s_mul_i32 s52, s52, 352
    s_mul_i32 s50, s55, 160
    s_add_u32 s52, s52, s50
    s_mul_i32 s50, s37, 44032
    s_add_u32 s52, s52, s50
    s_cmp_eq_u32 s55, 0
    s_cselect_b64 vcc, -1, 0
    v_add_u32 v26, 0, v1
    v_mul_u32_u24 v27, 171, v26
    v_lshrrev_b32 v27, 11, v27
    v_mul_u32_u24 v28, 12, v27
    v_sub_u32 v26, v26, v28
    v_lshrrev_b32 v28, 1, v26
    v_bfe_u32 v29, v27, 3, 1
    v_xor_b32 v28, v28, v29
    v_sub_u32 v29, 5, v28
    v_cndmask_b32 v28, v29, v28, vcc
    v_and_b32 v26, 1, v26
    v_lshlrev_b32 v26, 4, v26
    v_lshl_add_u32 v26, v28, 5, v26
    v_mul_u32_u24 v27, 2752, v27
    v_add3_u32 v6, v26, v27, s52
    s_sub_u32 s52, s52, 1024
    v_add_u32 v26, 64, v1
    v_mul_u32_u24 v27, 171, v26
    v_lshrrev_b32 v27, 11, v27
    v_mul_u32_u24 v28, 12, v27
    v_sub_u32 v26, v26, v28
    v_lshrrev_b32 v28, 1, v26
    v_bfe_u32 v29, v27, 3, 1
    v_xor_b32 v28, v28, v29
    v_sub_u32 v29, 5, v28
    v_cndmask_b32 v28, v29, v28, vcc
    v_and_b32 v26, 1, v26
    v_lshlrev_b32 v26, 4, v26
    v_lshl_add_u32 v26, v28, 5, v26
    v_mul_u32_u24 v27, 2752, v27
    v_add3_u32 v7, v26, v27, s52
    s_sub_u32 s52, s52, 1024
    v_add_u32 v26, 128, v1
    v_mul_u32_u24 v27, 171, v26
    v_lshrrev_b32 v27, 11, v27
    v_mul_u32_u24 v28, 12, v27
    v_sub_u32 v26, v26, v28
    v_lshrrev_b32 v28, 1, v26
    v_bfe_u32 v29, v27, 3, 1
    v_xor_b32 v28, v28, v29
    v_sub_u32 v29, 5, v28
    v_cndmask_b32 v28, v29, v28, vcc
    v_and_b32 v26, 1, v26
    v_lshlrev_b32 v26, 4, v26
    v_lshl_add_u32 v26, v28, 5, v26
    v_mul_u32_u24 v27, 2752, v27
    v_add3_u32 v8, v26, v27, s52
    s_sub_u32 s52, s52, 1024
    s_lshl_b32 s48, s40, 2
    s_lshr_b32 s49, s41, 3
    s_add_u32 s56, s48, s49
    s_and_b32 s57, s41, 7
    s_lshl_b32 s48, s56, 16
    s_lshl_b32 s49, s36, 13
    s_add_u32 s49, s48, s49
    s_add_u32 s58, s49, 2097152
    s_add_u32 s59, s49, 2101248
    s_add_u32 s60, s49, 4194304
    s_add_u32 s61, s49, 4198400
    s_lshl_b32 s49, s57, 13
    s_add_u32 s50, s48, s49
    s_sub_u32 s48, s36, 0
    s_and_b32 s48, s48, 7
    s_lshl_b32 s48, s48, 10
    s_add_u32 s64, s48, s50
    s_sub_u32 s48, s36, 1
    s_and_b32 s48, s48, 7
    s_lshl_b32 s48, s48, 10
    s_add_u32 s65, s48, s50
    s_sub_u32 s48, s36, 2
    s_and_b32 s48, s48, 7
    s_lshl_b32 s48, s48, 10
    s_add_u32 s66, s48, s50
    s_sub_u32 s48, s36, 3
    s_and_b32 s48, s48, 7
    s_lshl_b32 s48, s48, 10
    s_add_u32 s67, s48, s50
    s_sub_u32 s48, s36, 4
    s_and_b32 s48, s48, 7
    s_lshl_b32 s48, s48, 10
    s_add_u32 s68, s48, s50
    s_sub_u32 s48, s36, 5
    s_and_b32 s48, s48, 7
    s_lshl_b32 s48, s48, 10
    s_add_u32 s69, s48, s50
    s_sub_u32 s48, s36, 6
    s_and_b32 s48, s48, 7
    s_lshl_b32 s48, s48, 10
    s_add_u32 s70, s48, s50
    s_sub_u32 s48, s36, 7
    s_and_b32 s48, s48, 7
    s_lshl_b32 s48, s48, 10
    s_add_u32 s71, s48, s50
    s_add_u32 s48, s36, 1
    s_and_b32 s48, s48, 7
    s_lshl_b32 s49, s57, 3
    s_add_u32 s48, s48, s49
    s_lshl_b32 s48, s48, 5
    s_add_u32 s48, s48, s56
    s_lshl_b32 s49, s48, 10
    s_add_u32 s75, s49, 6291456
    s_and_b32 s48, s40, 3
    s_lshl_b32 s48, s48, 3
    s_and_b32 s49, s41, 7
    s_add_u32 s62, s48, s49
    s_lshr_b32 s48, s40, 2
    s_lshl_b32 s48, s48, 2
    s_lshr_b32 s49, s41, 3
    s_add_u32 s63, s48, s49
    s_and_b32 s73, s36, 1
    s_lshr_b32 s72, s36, 1
    s_lshl_b32 s48, s62, 1
    s_add_u32 s48, s48, s73
    s_mul_i32 s48, s48, 86
    s_mul_i32 s49, s72, 22
    s_add_u32 s48, s48, s49
    s_lshl_b32 s48, s48, 10
    s_add_u32 s74, s48, 8388608
    s_lshr_b32 s48, s56, 2
    s_lshl_b32 s48, s48, 5
    v_and_b32 v26, 1, v1
    v_lshrrev_b32 v0, 1, v1
    s_lshl_b32 s49, s36, 1
    v_add_u32 v0, s49, v0
    v_lshl_add_u32 v0, v26, 4, v0
    s_lshl_b32 s49, s57, 1
    v_add_u32 v26, s49, v26
    v_cmp_gt_u32 vcc, 4, v1
    s_add_u32 s48, s48, 57344
    s_nop 0
    v_cndmask_b32 v0, v26, v0, vcc
    v_add_lshl_u32 v0, v0, s48, 8
    s_add_u32 s53, s54, 1
    s_and_b32 s53, s53, 7
    s_add_u32 m0, s92, 28672
    s_mul_i32 s7, s53, 128
    buffer_load_dwordx4 v2, s[8:11], s7 offen offset:0 lds
    buffer_load_dwordx4 v3, s[8:11], s7 offen offset:1024 lds
    s_add_u32 m0, s93, 45056
    s_mul_i32 s7, s53, 196608
    buffer_load_dwordx4 v4, s[12:15], s7 offen offset:0 lds
    s_add_u32 m0, s94, 53248
    s_mov_b32 exec_hi, 0
    buffer_load_dwordx4 v5, s[12:15], s7 offen offset:0 lds
    s_mov_b32 exec_hi, -1
    s_cmp_lg_u32 s38, 0
    s_cbranch_scc1 L_a1_2
    v_add_u32 v100, s44, v13
    v_xor_b32 v101, 32, v100
    v_add_u32 v102, s44, v14
    v_xor_b32 v103, 32, v102
    v_add_u32 v104, s45, v13
    v_xor_b32 v105, 32, v104
    v_add_u32 v106, s45, v14
    v_xor_b32 v107, 32, v106
    v_lshrrev_b32 v112, 5, v1
    v_bfe_u32 v108, v1, 1, 1
    v_cmp_eq_u32 vcc, v112, v108
    v_mov_b32 v111, s39
    v_and_b32 v112, 1, v1
    v_cndmask_b32 v108, 0, v111, vcc
    v_cndmask_b32 v109, 0, v111, vcc
    v_cndmask_b32 v110, 0, v111, vcc
    v_cndmask_b32 v111, 0, v111, vcc
    v_mul_u32_u24 v112, 0xaaaa, v112
    v_add_u32 v112, 0x4444, v112
    v_mov_b32 v120, 0
    v_mov_b32 v121, 0
    v_mov_b32 v122, 0
    v_mov_b32 v123, 0
    s_lshr_b32 s50, s37, 1
    s_and_b32 s51, s37, 1
    s_lshl_b32 s48, s50, 6
    s_lshl_b32 s49, s51, 8
    s_add_u32 s48, s48, s49
    s_add_u32 s48, s48, 157696
    v_and_b32 v22, 15, v1
    v_lshl_add_u32 v16, v22, 2, s48
    s_lshl_b32 s52, s37, 8
    s_add_u32 s52, s52, 143360
    v_lshl_add_u32 v23, v22, 2, s52
    v_lshrrev_b32 v18, 4, v1
    s_add_u32 s48, s49, 157696
    s_lshl_b32 s49, s42, 2
    s_add_u32 s49, s49, s37
    s_lshl_b32 s49, s49, 10
    v_lshl_add_u32 v19, v18, 4, s48
    v_xor_b32 v20, 0x100, v19
    s_lshl_b32 s48, s55, 21
    s_add_u32 s49, s49, s48
    s_lshr_b32 s48, s43, 1
    s_lshl_b32 s48, s48, 18
    s_add_u32 s49, s49, s48
    s_lshl_b32 s48, s51, 17
    s_add_u32 s80, s49, s48
    s_xor_b32 s48, s48, 0x20000
    s_add_u32 s82, s49, s48
    s_add_u32 s81, s80, 0x10000
    s_add_u32 s83, s82, 0x10000
    s_lshl_b32 s48, s55, 8
    v_lshlrev_b32 v17, 4, v1
    v_xor_b32 v17, s48, v17
    s_cmp_eq_u32 s55, 0
    s_cselect_b32 s0, 0x3eb8aa3b, 1.0
    s_waitcnt lgkmcnt(0)
    s_mul_i32 s3, s3, 0x9e3779b1
    s_add_u32 s3, s3, 0x7f4a7c15
    s_waitcnt vmcnt(4)
    s_barrier
    ds_read_b128 v[128:131], v9 offset:0
    ds_read_b128 v[132:135], v10 offset:0
    ds_read_b64_tr_b16 v[32:33], v100 offset:0
    ds_read_b64_tr_b16 v[34:35], v100 offset:512
    ds_read_b64_tr_b16 v[36:37], v101 offset:0
    ds_read_b64_tr_b16 v[38:39], v101 offset:512
    ds_read_b64_tr_b16 v[44:45], v102 offset:0
    ds_read_b64_tr_b16 v[46:47], v102 offset:512
    ds_read_b64_tr_b16 v[48:49], v103 offset:0
    ds_read_b64_tr_b16 v[50:51], v103 offset:512
    s_waitcnt lgkmcnt(4)
    v_mfma_f32_16x16x32_bf16 v[68:71], v[32:35], v[128:131], 0
    ds_read_b64_tr_b16 v[56:57], v104 offset:0
    v_mfma_f32_16x16x32_bf16 v[72:75], v[32:35], v[132:135], 0
    ds_read_b64_tr_b16 v[58:59], v104 offset:512
    ds_read_b128 v[136:139], v11 offset:0
    ds_read_b128 v[140:143], v12 offset:0
    s_add_u32 s53, s54, 2
    s_and_b32 s53, s53, 7
    s_add_u32 m0, s92, 57344
    s_mul_i32 s7, s53, 128
    buffer_load_dwordx4 v2, s[8:11], s7 offen offset:0 lds
    v_mfma_f32_16x16x32_bf16 v[76:79], v[36:39], v[128:131], 0
    ds_read_b64_tr_b16 v[60:61], v105 offset:0
    v_mfma_f32_16x16x32_bf16 v[80:83], v[36:39], v[132:135], 0
    ds_read_b64_tr_b16 v[62:63], v105 offset:512
    buffer_load_dwordx4 v3, s[8:11], s7 offen offset:1024 lds
    v_smfmac_f32_16x16x64_bf16 v[120:123], v[108:111], v[32:39], v112
    s_waitcnt lgkmcnt(6)
    v_mfma_f32_16x16x32_bf16 v[84:87], v[44:47], v[128:131], 0
    ds_read_b64_tr_b16 v[32:33], v106 offset:0
    v_mfma_f32_16x16x32_bf16 v[88:91], v[44:47], v[132:135], 0
    ds_read_b64_tr_b16 v[34:35], v106 offset:512
    s_add_u32 m0, s93, 73728
    s_mul_i32 s7, s53, 196608
    buffer_load_dwordx4 v4, s[12:15], s7 offen offset:0 lds
    v_mfma_f32_16x16x32_bf16 v[92:95], v[48:51], v[128:131], 0
    ds_read_b64_tr_b16 v[36:37], v107 offset:0
    v_mfma_f32_16x16x32_bf16 v[96:99], v[48:51], v[132:135], 0
    ds_read_b64_tr_b16 v[38:39], v107 offset:512
    s_add_u32 m0, s94, 81920
    s_mov_b32 exec_hi, 0
    buffer_load_dwordx4 v5, s[12:15], s7 offen offset:0 lds
    s_mov_b32 exec_hi, -1
    s_waitcnt vmcnt(4)
    s_barrier
    s_waitcnt lgkmcnt(4)
    v_mfma_f32_16x16x32_bf16 v[68:71], v[56:59], v[136:139], v[68:71]
    ds_read_b64_tr_b16 v[44:45], v100 offset:28672
    v_mfma_f32_16x16x32_bf16 v[72:75], v[56:59], v[140:143], v[72:75]
    ds_read_b64_tr_b16 v[46:47], v100 offset:29184
    ds_read_b128 v[144:147], v9 offset:28672
    ds_read_b128 v[148:151], v10 offset:28672
    s_add_u32 s53, s54, 3
    s_and_b32 s53, s53, 7
    s_add_u32 m0, s92, 86016
    s_mul_i32 s7, s53, 128
    buffer_load_dwordx4 v2, s[8:11], s7 offen offset:0 lds
    v_mfma_f32_16x16x32_bf16 v[76:79], v[60:63], v[136:139], v[76:79]
    ds_read_b64_tr_b16 v[48:49], v101 offset:28672
    v_mfma_f32_16x16x32_bf16 v[80:83], v[60:63], v[140:143], v[80:83]
    ds_read_b64_tr_b16 v[50:51], v101 offset:29184
    buffer_load_dwordx4 v3, s[8:11], s7 offen offset:1024 lds
    s_waitcnt lgkmcnt(6)
    v_mfma_f32_16x16x32_bf16 v[84:87], v[32:35], v[136:139], v[84:87]
    ds_read_b64_tr_b16 v[56:57], v102 offset:28672
    v_mfma_f32_16x16x32_bf16 v[88:91], v[32:35], v[140:143], v[88:91]
    ds_read_b64_tr_b16 v[58:59], v102 offset:29184
    s_add_u32 m0, s93, 102400
    s_mul_i32 s7, s53, 196608
    buffer_load_dwordx4 v4, s[12:15], s7 offen offset:0 lds
    v_mfma_f32_16x16x32_bf16 v[92:95], v[36:39], v[136:139], v[92:95]
    ds_read_b64_tr_b16 v[60:61], v103 offset:28672
    v_mfma_f32_16x16x32_bf16 v[96:99], v[36:39], v[140:143], v[96:99]
    ds_read_b64_tr_b16 v[62:63], v103 offset:29184
    s_add_u32 m0, s94, 110592
    s_mov_b32 exec_hi, 0
    buffer_load_dwordx4 v5, s[12:15], s7 offen offset:0 lds
    s_mov_b32 exec_hi, -1
    s_waitcnt lgkmcnt(4)
    v_mfma_f32_16x16x32_bf16 v[68:71], v[44:47], v[144:147], v[68:71]
    ds_read_b64_tr_b16 v[32:33], v104 offset:28672
    v_mfma_f32_16x16x32_bf16 v[72:75], v[44:47], v[148:151], v[72:75]
    ds_read_b64_tr_b16 v[34:35], v104 offset:29184
    ds_read_b128 v[152:155], v11 offset:28672
    ds_read_b128 v[156:159], v12 offset:28672
    s_add_u32 s53, s54, 4
    s_and_b32 s53, s53, 7
    s_add_u32 m0, s92, 114688
    s_mul_i32 s7, s53, 128
    buffer_load_dwordx4 v2, s[8:11], s7 offen offset:0 lds
    v_mfma_f32_16x16x32_bf16 v[76:79], v[48:51], v[144:147], v[76:79]
    ds_read_b64_tr_b16 v[36:37], v105 offset:28672
    v_mfma_f32_16x16x32_bf16 v[80:83], v[48:51], v[148:151], v[80:83]
    ds_read_b64_tr_b16 v[38:39], v105 offset:29184
    v_smfmac_f32_16x16x64_bf16 v[120:123], v[108:111], v[44:51], v112
    s_waitcnt lgkmcnt(6)
    v_mfma_f32_16x16x32_bf16 v[84:87], v[56:59], v[144:147], v[84:87]
    ds_read_b64_tr_b16 v[44:45], v106 offset:28672
    v_mfma_f32_16x16x32_bf16 v[88:91], v[56:59], v[148:151], v[88:91]
    ds_read_b64_tr_b16 v[46:47], v106 offset:29184
    buffer_load_dwordx4 v3, s[8:11], s7 offen offset:1024 lds
    v_mfma_f32_16x16x32_bf16 v[92:95], v[60:63], v[144:147], v[92:95]
    ds_read_b64_tr_b16 v[48:49], v107 offset:28672
    v_mfma_f32_16x16x32_bf16 v[96:99], v[60:63], v[148:151], v[96:99]
    ds_read_b64_tr_b16 v[50:51], v107 offset:29184
    s_waitcnt vmcnt(6)
    s_barrier
    s_waitcnt lgkmcnt(4)
    v_mfma_f32_16x16x32_bf16 v[68:71], v[32:35], v[152:155], v[68:71]
    ds_read_b64_tr_b16 v[56:57], v100 offset:57344
    v_mfma_f32_16x16x32_bf16 v[72:75], v[32:35], v[156:159], v[72:75]
    ds_read_b64_tr_b16 v[58:59], v100 offset:57856
    ds_read_b128 v[160:163], v9 offset:57344
    ds_read_b128 v[164:167], v10 offset:57344
    s_add_u32 m0, s93, 131072
    s_mul_i32 s7, s53, 196608
    buffer_load_dwordx4 v4, s[12:15], s7 offen offset:0 lds
    v_mfma_f32_16x16x32_bf16 v[76:79], v[36:39], v[152:155], v[76:79]
    ds_read_b64_tr_b16 v[60:61], v101 offset:57344
    v_mfma_f32_16x16x32_bf16 v[80:83], v[36:39], v[156:159], v[80:83]
    ds_read_b64_tr_b16 v[62:63], v101 offset:57856
    s_add_u32 m0, s94, 139264
    s_mov_b32 exec_hi, 0
    buffer_load_dwordx4 v5, s[12:15], s7 offen offset:0 lds
    s_mov_b32 exec_hi, -1
    s_waitcnt lgkmcnt(6)
    v_mfma_f32_16x16x32_bf16 v[84:87], v[44:47], v[152:155], v[84:87]
    ds_read_b64_tr_b16 v[32:33], v102 offset:57344
    v_mfma_f32_16x16x32_bf16 v[88:91], v[44:47], v[156:159], v[88:91]
    ds_read_b64_tr_b16 v[34:35], v102 offset:57856
    s_add_u32 s53, s54, 5
    s_and_b32 s53, s53, 7
    s_add_u32 m0, s92, 0
    s_mul_i32 s7, s53, 128
    buffer_load_dwordx4 v2, s[8:11], s7 offen offset:0 lds
    v_mfma_f32_16x16x32_bf16 v[92:95], v[48:51], v[152:155], v[92:95]
    ds_read_b64_tr_b16 v[36:37], v103 offset:57344
    v_mfma_f32_16x16x32_bf16 v[96:99], v[48:51], v[156:159], v[96:99]
    ds_read_b64_tr_b16 v[38:39], v103 offset:57856
    s_waitcnt lgkmcnt(4)
    v_mfma_f32_16x16x32_bf16 v[68:71], v[56:59], v[160:163], v[68:71]
    ds_read_b64_tr_b16 v[44:45], v104 offset:57344
    v_mfma_f32_16x16x32_bf16 v[72:75], v[56:59], v[164:167], v[72:75]
    ds_read_b64_tr_b16 v[46:47], v104 offset:57856
    ds_read_b128 v[168:171], v11 offset:57344
    ds_read_b128 v[172:175], v12 offset:57344
    buffer_load_dwordx4 v3, s[8:11], s7 offen offset:1024 lds
    v_mfma_f32_16x16x32_bf16 v[76:79], v[60:63], v[160:163], v[76:79]
    ds_read_b64_tr_b16 v[48:49], v105 offset:57344
    v_mfma_f32_16x16x32_bf16 v[80:83], v[60:63], v[164:167], v[80:83]
    ds_read_b64_tr_b16 v[50:51], v105 offset:57856
    v_smfmac_f32_16x16x64_bf16 v[120:123], v[108:111], v[56:63], v112
    s_waitcnt lgkmcnt(6)
    v_mfma_f32_16x16x32_bf16 v[84:87], v[32:35], v[160:163], v[84:87]
    ds_read_b64_tr_b16 v[56:57], v106 offset:57344
    v_mfma_f32_16x16x32_bf16 v[88:91], v[32:35], v[164:167], v[88:91]
    ds_read_b64_tr_b16 v[58:59], v106 offset:57856
    s_add_u32 m0, s93, 16384
    s_mul_i32 s7, s53, 196608
    buffer_load_dwordx4 v4, s[12:15], s7 offen offset:0 lds
    v_mfma_f32_16x16x32_bf16 v[92:95], v[36:39], v[160:163], v[92:95]
    ds_read_b64_tr_b16 v[60:61], v107 offset:57344
    v_mfma_f32_16x16x32_bf16 v[96:99], v[36:39], v[164:167], v[96:99]
    ds_read_b64_tr_b16 v[62:63], v107 offset:57856
    s_waitcnt vmcnt(7)
    s_barrier
    s_waitcnt lgkmcnt(4)
    v_add_u32 v100, 0x10000, v100
    v_add_u32 v101, 0x10000, v101
    v_mfma_f32_16x16x32_bf16 v[68:71], v[44:47], v[168:171], v[68:71]
    ds_read_b64_tr_b16 v[32:33], v100 offset:20480
    v_mfma_f32_16x16x32_bf16 v[72:75], v[44:47], v[172:175], v[72:75]
    ds_read_b64_tr_b16 v[34:35], v100 offset:20992
    v_add_u32 v9, 0x10000, v9
    ds_read_b128 v[176:179], v9 offset:20480
    v_add_u32 v10, 0x10000, v10
    ds_read_b128 v[180:183], v10 offset:20480
    s_add_u32 m0, s94, 24576
    s_mov_b32 exec_hi, 0
    buffer_load_dwordx4 v5, s[12:15], s7 offen offset:0 lds
    s_mov_b32 exec_hi, -1
    v_mfma_f32_16x16x32_bf16 v[76:79], v[48:51], v[168:171], v[76:79]
    ds_read_b64_tr_b16 v[36:37], v101 offset:20480
    v_mfma_f32_16x16x32_bf16 v[80:83], v[48:51], v[172:175], v[80:83]
    ds_read_b64_tr_b16 v[38:39], v101 offset:20992
    s_add_u32 s53, s54, 6
    s_and_b32 s53, s53, 7
    s_add_u32 m0, s92, 28672
    s_mul_i32 s7, s53, 128
    buffer_load_dwordx4 v2, s[8:11], s7 offen offset:0 lds
    s_waitcnt lgkmcnt(6)
    v_add_u32 v102, 0x10000, v102
    v_add_u32 v103, 0x10000, v103
    v_mfma_f32_16x16x32_bf16 v[84:87], v[56:59], v[168:171], v[84:87]
    ds_read_b64_tr_b16 v[44:45], v102 offset:20480
    v_mfma_f32_16x16x32_bf16 v[88:91], v[56:59], v[172:175], v[88:91]
    ds_read_b64_tr_b16 v[46:47], v102 offset:20992
    buffer_load_dwordx4 v3, s[8:11], s7 offen offset:1024 lds
    v_mfma_f32_16x16x32_bf16 v[92:95], v[60:63], v[168:171], v[92:95]
    ds_read_b64_tr_b16 v[48:49], v103 offset:20480
    v_mfma_f32_16x16x32_bf16 v[96:99], v[60:63], v[172:175], v[96:99]
    ds_read_b64_tr_b16 v[50:51], v103 offset:20992
    s_waitcnt lgkmcnt(4)
    v_add_u32 v104, 0x10000, v104
    v_add_u32 v105, 0x10000, v105
    v_mfma_f32_16x16x32_bf16 v[68:71], v[32:35], v[176:179], v[68:71]
    ds_read_b64_tr_b16 v[56:57], v104 offset:20480
    v_mfma_f32_16x16x32_bf16 v[72:75], v[32:35], v[180:183], v[72:75]
    ds_read_b64_tr_b16 v[58:59], v104 offset:20992
    v_add_u32 v11, 0x10000, v11
    ds_read_b128 v[184:187], v11 offset:20480
    v_add_u32 v12, 0x10000, v12
    ds_read_b128 v[188:191], v12 offset:20480
    s_add_u32 m0, s93, 45056
    s_mul_i32 s7, s53, 196608
    buffer_load_dwordx4 v4, s[12:15], s7 offen offset:0 lds
    v_mfma_f32_16x16x32_bf16 v[76:79], v[36:39], v[176:179], v[76:79]
    ds_read_b64_tr_b16 v[60:61], v105 offset:20480
    v_mfma_f32_16x16x32_bf16 v[80:83], v[36:39], v[180:183], v[80:83]
    ds_read_b64_tr_b16 v[62:63], v105 offset:20992
    v_smfmac_f32_16x16x64_bf16 v[120:123], v[108:111], v[32:39], v112
    s_waitcnt lgkmcnt(6)
    v_add_u32 v106, 0x10000, v106
    v_add_u32 v107, 0x10000, v107
    v_mfma_f32_16x16x32_bf16 v[84:87], v[44:47], v[176:179], v[84:87]
    ds_read_b64_tr_b16 v[32:33], v106 offset:20480
    v_mfma_f32_16x16x32_bf16 v[88:91], v[44:47], v[180:183], v[88:91]
    ds_read_b64_tr_b16 v[34:35], v106 offset:20992
    s_add_u32 m0, s94, 53248
    s_mov_b32 exec_hi, 0
    buffer_load_dwordx4 v5, s[12:15], s7 offen offset:0 lds
    s_mov_b32 exec_hi, -1
    v_mfma_f32_16x16x32_bf16 v[92:95], v[48:51], v[176:179], v[92:95]
    ds_read_b64_tr_b16 v[36:37], v107 offset:20480
    v_mfma_f32_16x16x32_bf16 v[96:99], v[48:51], v[180:183], v[96:99]
    ds_read_b64_tr_b16 v[38:39], v107 offset:20992
    s_waitcnt vmcnt(8)
    s_barrier
    s_waitcnt lgkmcnt(4)
    v_mfma_f32_16x16x32_bf16 v[68:71], v[56:59], v[184:187], v[68:71]
    ds_read_b64_tr_b16 v[44:45], v100 offset:49152
    v_mfma_f32_16x16x32_bf16 v[72:75], v[56:59], v[188:191], v[72:75]
    ds_read_b64_tr_b16 v[46:47], v100 offset:49664
    ds_read_b128 v[192:195], v9 offset:49152
    ds_read_b128 v[196:199], v10 offset:49152
    s_add_u32 s53, s54, 7
    s_and_b32 s53, s53, 7
    s_add_u32 m0, s92, 57344
    s_mul_i32 s7, s53, 128
    buffer_load_dwordx4 v2, s[8:11], s7 offen offset:0 lds
    v_mfma_f32_16x16x32_bf16 v[76:79], v[60:63], v[184:187], v[76:79]
    ds_read_b64_tr_b16 v[48:49], v101 offset:49152
    v_mfma_f32_16x16x32_bf16 v[80:83], v[60:63], v[188:191], v[80:83]
    ds_read_b64_tr_b16 v[50:51], v101 offset:49664
    s_waitcnt lgkmcnt(6)
    v_mfma_f32_16x16x32_bf16 v[84:87], v[32:35], v[184:187], v[84:87]
    ds_read_b64_tr_b16 v[56:57], v102 offset:49152
    v_mfma_f32_16x16x32_bf16 v[88:91], v[32:35], v[188:191], v[88:91]
    ds_read_b64_tr_b16 v[58:59], v102 offset:49664
    buffer_load_dwordx4 v3, s[8:11], s7 offen offset:1024 lds
    v_mfma_f32_16x16x32_bf16 v[92:95], v[36:39], v[184:187], v[92:95]
    ds_read_b64_tr_b16 v[60:61], v103 offset:49152
    v_mfma_f32_16x16x32_bf16 v[96:99], v[36:39], v[188:191], v[96:99]
    ds_read_b64_tr_b16 v[62:63], v103 offset:49664
    s_waitcnt lgkmcnt(4)
    v_mfma_f32_16x16x32_bf16 v[68:71], v[44:47], v[192:195], v[68:71]
    ds_read_b64_tr_b16 v[32:33], v104 offset:49152
    v_mfma_f32_16x16x32_bf16 v[72:75], v[44:47], v[196:199], v[72:75]
    ds_read_b64_tr_b16 v[34:35], v104 offset:49664
    ds_read_b128 v[200:203], v11 offset:49152
    ds_read_b128 v[204:207], v12 offset:49152
    s_add_u32 m0, s93, 73728
    s_mul_i32 s7, s53, 196608
    buffer_load_dwordx4 v4, s[12:15], s7 offen offset:0 lds
    v_mfma_f32_16x16x32_bf16 v[76:79], v[48:51], v[192:195], v[76:79]
    ds_read_b64_tr_b16 v[36:37], v105 offset:49152
    v_mfma_f32_16x16x32_bf16 v[80:83], v[48:51], v[196:199], v[80:83]
    ds_read_b64_tr_b16 v[38:39], v105 offset:49664
    v_smfmac_f32_16x16x64_bf16 v[120:123], v[108:111], v[44:51], v112
    s_waitcnt lgkmcnt(6)
    v_mfma_f32_16x16x32_bf16 v[84:87], v[56:59], v[192:195], v[84:87]
    ds_read_b64_tr_b16 v[44:45], v106 offset:49152
    v_mfma_f32_16x16x32_bf16 v[88:91], v[56:59], v[196:199], v[88:91]
    ds_read_b64_tr_b16 v[46:47], v106 offset:49664
    s_add_u32 m0, s94, 81920
    s_mov_b32 exec_hi, 0
    buffer_load_dwordx4 v5, s[12:15], s7 offen offset:0 lds
    s_mov_b32 exec_hi, -1
    v_mfma_f32_16x16x32_bf16 v[92:95], v[60:63], v[192:195], v[92:95]
    ds_read_b64_tr_b16 v[48:49], v107 offset:49152
    v_mfma_f32_16x16x32_bf16 v[96:99], v[60:63], v[196:199], v[96:99]
    ds_read_b64_tr_b16 v[50:51], v107 offset:49664
    s_waitcnt vmcnt(8)
    s_barrier
    s_waitcnt lgkmcnt(4)
    v_add_u32 v100, 0xffff0000, v100
    v_add_u32 v101, 0xffff0000, v101
    v_mfma_f32_16x16x32_bf16 v[68:71], v[32:35], v[200:203], v[68:71]
    ds_read_b64_tr_b16 v[56:57], v100 offset:0
    v_mfma_f32_16x16x32_bf16 v[72:75], v[32:35], v[204:207], v[72:75]
    ds_read_b64_tr_b16 v[58:59], v100 offset:512
    v_add_u32 v9, 0xffff0000, v9
    ds_read_b128 v[208:211], v9 offset:0
    v_add_u32 v10, 0xffff0000, v10
    ds_read_b128 v[212:215], v10 offset:0
    s_add_u32 s53, s54, 0
    s_and_b32 s53, s53, 7
    s_add_u32 m0, s95, 86016
    s_mul_i32 s7, s53, 176128
    buffer_load_dwordx4 v6, s[16:19], s7 offen offset:0 lds
    v_mfma_f32_16x16x32_bf16 v[76:79], v[36:39], v[200:203], v[76:79]
    ds_read_b64_tr_b16 v[60:61], v101 offset:0
    v_mfma_f32_16x16x32_bf16 v[80:83], v[36:39], v[204:207], v[80:83]
    ds_read_b64_tr_b16 v[62:63], v101 offset:512
    s_waitcnt lgkmcnt(6)
    v_add_u32 v102, 0xffff0000, v102
    v_add_u32 v103, 0xffff0000, v103
    v_mfma_f32_16x16x32_bf16 v[84:87], v[44:47], v[200:203], v[84:87]
    ds_read_b64_tr_b16 v[32:33], v102 offset:0
    v_mfma_f32_16x16x32_bf16 v[88:91], v[44:47], v[204:207], v[88:91]
    ds_read_b64_tr_b16 v[34:35], v102 offset:512
    buffer_load_dwordx4 v7, s[16:19], s7 offen offset:1024 lds
    v_mfma_f32_16x16x32_bf16 v[92:95], v[48:51], v[200:203], v[92:95]
    ds_read_b64_tr_b16 v[36:37], v103 offset:0
    v_mfma_f32_16x16x32_bf16 v[96:99], v[48:51], v[204:207], v[96:99]
    ds_read_b64_tr_b16 v[38:39], v103 offset:512
    s_waitcnt lgkmcnt(4)
    v_add_u32 v104, 0xffff0000, v104
    v_add_u32 v105, 0xffff0000, v105
    v_mfma_f32_16x16x32_bf16 v[68:71], v[56:59], v[208:211], v[68:71]
    ds_read_b64_tr_b16 v[44:45], v104 offset:0
    v_mfma_f32_16x16x32_bf16 v[72:75], v[56:59], v[212:215], v[72:75]
    ds_read_b64_tr_b16 v[46:47], v104 offset:512
    v_add_u32 v11, 0xffff0000, v11
    ds_read_b128 v[216:219], v11 offset:0
    v_add_u32 v12, 0xffff0000, v12
    ds_read_b128 v[220:223], v12 offset:0
    buffer_load_dwordx4 v8, s[16:19], s7 offen offset:2048 lds
    v_mfma_f32_16x16x32_bf16 v[76:79], v[60:63], v[208:211], v[76:79]
    ds_read_b64_tr_b16 v[48:49], v105 offset:0
    v_mfma_f32_16x16x32_bf16 v[80:83], v[60:63], v[212:215], v[80:83]
    ds_read_b64_tr_b16 v[50:51], v105 offset:512
    v_smfmac_f32_16x16x64_bf16 v[120:123], v[108:111], v[56:63], v112
    s_waitcnt lgkmcnt(6)
    v_add_u32 v106, 0xffff0000, v106
    v_add_u32 v107, 0xffff0000, v107
    v_mfma_f32_16x16x32_bf16 v[84:87], v[32:35], v[208:211], v[84:87]
    ds_read_b64_tr_b16 v[56:57], v106 offset:0
    v_mfma_f32_16x16x32_bf16 v[88:91], v[32:35], v[212:215], v[88:91]
    ds_read_b64_tr_b16 v[58:59], v106 offset:512
    v_mfma_f32_16x16x32_bf16 v[92:95], v[36:39], v[208:211], v[92:95]
    ds_read_b64_tr_b16 v[60:61], v107 offset:0
    v_mfma_f32_16x16x32_bf16 v[96:99], v[36:39], v[212:215], v[96:99]
    ds_read_b64_tr_b16 v[62:63], v107 offset:512
    s_waitcnt vmcnt(7)
    s_barrier
    s_waitcnt lgkmcnt(4)
    v_mfma_f32_16x16x32_bf16 v[68:71], v[44:47], v[216:219], v[68:71]
    ds_read_b64_tr_b16 v[32:33], v100 offset:28672
    v_mfma_f32_16x16x32_bf16 v[72:75], v[44:47], v[220:223], v[72:75]
    ds_read_b64_tr_b16 v[34:35], v100 offset:29184
    ds_read_b128 v[224:227], v9 offset:28672
    ds_read_b128 v[228:231], v10 offset:28672
    v_mfma_f32_16x16x32_bf16 v[76:79], v[48:51], v[216:219], v[76:79]
    ds_read_b64_tr_b16 v[36:37], v101 offset:28672
    v_mfma_f32_16x16x32_bf16 v[80:83], v[48:51], v[220:223], v[80:83]
    ds_read_b64_tr_b16 v[38:39], v101 offset:29184
    s_waitcnt lgkmcnt(6)
    v_mfma_f32_16x16x32_bf16 v[84:87], v[56:59], v[216:219], v[84:87]
    ds_read_b64_tr_b16 v[44:45], v102 offset:28672
    v_mfma_f32_16x16x32_bf16 v[88:91], v[56:59], v[220:223], v[88:91]
    ds_read_b64_tr_b16 v[46:47], v102 offset:29184
    v_mfma_f32_16x16x32_bf16 v[92:95], v[60:63], v[216:219], v[92:95]
    ds_read_b64_tr_b16 v[48:49], v103 offset:28672
    v_mfma_f32_16x16x32_bf16 v[96:99], v[60:63], v[220:223], v[96:99]
    ds_read_b64_tr_b16 v[50:51], v103 offset:29184
    s_waitcnt lgkmcnt(4)
    v_mfma_f32_16x16x32_bf16 v[68:71], v[32:35], v[224:227], v[68:71]
    ds_read_b64_tr_b16 v[56:57], v104 offset:28672
    v_mfma_f32_16x16x32_bf16 v[72:75], v[32:35], v[228:231], v[72:75]
    ds_read_b64_tr_b16 v[58:59], v104 offset:29184
    ds_read_b128 v[232:235], v11 offset:28672
    ds_read_b128 v[236:239], v12 offset:28672
    v_mfma_f32_16x16x32_bf16 v[76:79], v[36:39], v[224:227], v[76:79]
    ds_read_b64_tr_b16 v[60:61], v105 offset:28672
    v_mfma_f32_16x16x32_bf16 v[80:83], v[36:39], v[228:231], v[80:83]
    ds_read_b64_tr_b16 v[62:63], v105 offset:29184
    v_smfmac_f32_16x16x64_bf16 v[120:123], v[108:111], v[32:39], v112
    s_waitcnt lgkmcnt(6)
    v_mfma_f32_16x16x32_bf16 v[84:87], v[44:47], v[224:227], v[84:87]
    ds_read_b64_tr_b16 v[32:33], v106 offset:28672
    v_mfma_f32_16x16x32_bf16 v[88:91], v[44:47], v[228:231], v[88:91]
    ds_read_b64_tr_b16 v[34:35], v106 offset:29184
    v_mfma_f32_16x16x32_bf16 v[92:95], v[48:51], v[224:227], v[92:95]
    ds_read_b64_tr_b16 v[36:37], v107 offset:28672
    v_mfma_f32_16x16x32_bf16 v[96:99], v[48:51], v[228:231], v[96:99]
    ds_read_b64_tr_b16 v[38:39], v107 offset:29184
    s_waitcnt vmcnt(3)
    s_barrier
    s_waitcnt lgkmcnt(4)
    v_mfma_f32_16x16x32_bf16 v[68:71], v[56:59], v[232:235], v[68:71]
    ds_read_b64_tr_b16 v[44:45], v100 offset:57344
    v_mfma_f32_16x16x32_bf16 v[72:75], v[56:59], v[236:239], v[72:75]
    ds_read_b64_tr_b16 v[46:47], v100 offset:57856
    ds_read_b128 v[240:243], v9 offset:57344
    ds_read_b128 v[244:247], v10 offset:57344
    ds_read_b128 v[248:251], v11 offset:57344
    ds_read_b128 v[252:255], v12 offset:57344
    s_add_u32 s53, s54, 1
    s_and_b32 s53, s53, 7
    s_add_u32 m0, s95, 114688
    s_mul_i32 s7, s53, 176128
    buffer_load_dwordx4 v6, s[16:19], s7 offen offset:0 lds
    v_mfma_f32_16x16x32_bf16 v[76:79], v[60:63], v[232:235], v[76:79]
    ds_read_b64_tr_b16 v[48:49], v101 offset:57344
    v_mfma_f32_16x16x32_bf16 v[80:83], v[60:63], v[236:239], v[80:83]
    ds_read_b64_tr_b16 v[50:51], v101 offset:57856
    s_waitcnt lgkmcnt(8)
    v_mfma_f32_16x16x32_bf16 v[84:87], v[32:35], v[232:235], v[84:87]
    ds_read_b64_tr_b16 v[56:57], v102 offset:57344
    v_mfma_f32_16x16x32_bf16 v[88:91], v[32:35], v[236:239], v[88:91]
    ds_read_b64_tr_b16 v[58:59], v102 offset:57856
    buffer_load_dwordx4 v7, s[16:19], s7 offen offset:1024 lds
    v_mfma_f32_16x16x32_bf16 v[92:95], v[36:39], v[232:235], v[92:95]
    ds_read_b64_tr_b16 v[60:61], v103 offset:57344
    v_mfma_f32_16x16x32_bf16 v[96:99], v[36:39], v[236:239], v[96:99]
    ds_read_b64_tr_b16 v[62:63], v103 offset:57856
    s_waitcnt lgkmcnt(4)
    v_mfma_f32_16x16x32_bf16 v[68:71], v[44:47], v[240:243], v[68:71]
    ds_read_b64_tr_b16 v[32:33], v104 offset:57344
    v_mfma_f32_16x16x32_bf16 v[72:75], v[44:47], v[244:247], v[72:75]
    ds_read_b64_tr_b16 v[34:35], v104 offset:57856
    buffer_load_dwordx4 v8, s[16:19], s7 offen offset:2048 lds
    v_mfma_f32_16x16x32_bf16 v[76:79], v[48:51], v[240:243], v[76:79]
    ds_read_b64_tr_b16 v[36:37], v105 offset:57344
    v_mfma_f32_16x16x32_bf16 v[80:83], v[48:51], v[244:247], v[80:83]
    ds_read_b64_tr_b16 v[38:39], v105 offset:57856
    v_smfmac_f32_16x16x64_bf16 v[120:123], v[108:111], v[44:51], v112
    s_waitcnt lgkmcnt(4)
    v_mfma_f32_16x16x32_bf16 v[84:87], v[56:59], v[240:243], v[84:87]
    ds_read_b64_tr_b16 v[44:45], v106 offset:57344
    v_mfma_f32_16x16x32_bf16 v[88:91], v[56:59], v[244:247], v[88:91]
    ds_read_b64_tr_b16 v[46:47], v106 offset:57856
    s_add_u32 s53, s54, 2
    s_and_b32 s53, s53, 7
    s_add_u32 m0, s95, 0
    s_mul_i32 s7, s53, 176128
    buffer_load_dwordx4 v6, s[16:19], s7 offen offset:0 lds
    v_mfma_f32_16x16x32_bf16 v[92:95], v[60:63], v[240:243], v[92:95]
    ds_read_b64_tr_b16 v[48:49], v107 offset:57344
    v_mfma_f32_16x16x32_bf16 v[96:99], v[60:63], v[244:247], v[96:99]
    ds_read_b64_tr_b16 v[50:51], v107 offset:57856
    v_add_f32 v120, v120, v121
    v_add_f32 v124, v122, v123
    ds_write_b32 v16, v120 offset:0
    ds_write_b32 v16, v124 offset:128
    s_waitcnt lgkmcnt(0)
    s_waitcnt vmcnt(4)
    s_barrier
    s_add_u32 s48, s88, 0x10000
    v_add_u32 v9, s48, v15
    v_add_u32 v10, s48, v21
    s_add_u32 s48, s89, 0x10000
    v_add_u32 v11, s48, v15
    v_add_u32 v12, s48, v21
    s_add_u32 s48, s90, 0x10000
    v_add_u32 v13, s48, v15
    v_add_u32 v14, s48, v21
    s_add_u32 s48, s91, 0x10000
    v_add_u32 v15, s48, v15
    v_add_u32 v21, s48, v21
    v_mfma_f32_16x16x32_bf16 v[68:71], v[32:35], v[248:251], v[68:71]
    ds_read_b64_tr_b16 v[56:57], v9 offset:20480
    v_mfma_f32_16x16x32_bf16 v[72:75], v[32:35], v[252:255], v[72:75]
    ds_read_b64_tr_b16 v[58:59], v9 offset:21248
    ds_read_b32 v24, v23 offset:0
    ds_read_b32 v25, v23 offset:64
    ds_read_b32 v26, v23 offset:128
    ds_read_b32 v27, v23 offset:192
    ds_read_b128 v[100:103], v19 offset:0
    ds_read_b128 v[120:123], v19 offset:64
    ds_read_b128 v[104:107], v19 offset:128
    ds_read_b128 v[124:127], v19 offset:192
    ds_read_b128 v[108:111], v20 offset:0
    ds_read_b128 v[52:55], v20 offset:64
    ds_read_b128 v[112:115], v20 offset:128
    ds_read_b128 v[28:31], v20 offset:192
    s_waitcnt lgkmcnt(10)
    v_mfma_f32_16x16x32_bf16 v[76:79], v[36:39], v[248:251], v[76:79]
    ds_read_b64_tr_b16 v[60:61], v10 offset:20512
    v_mfma_f32_16x16x32_bf16 v[80:83], v[36:39], v[252:255], v[80:83]
    ds_read_b64_tr_b16 v[62:63], v10 offset:21280
    buffer_load_dwordx4 v7, s[16:19], s7 offen offset:1024 lds
    ds_read_b64_tr_b16 v[64:65], v9 offset:20544
    ds_read_b64_tr_b16 v[66:67], v9 offset:21312
    s_waitcnt lgkmcnt(10)
    buffer_load_dwordx4 v8, s[16:19], s7 offen offset:2048 lds
    v_mfma_f32_16x16x32_bf16 v[84:87], v[44:47], v[248:251], v[84:87]
    ds_read_b64_tr_b16 v[32:33], v11 offset:20480
    v_mfma_f32_16x16x32_bf16 v[88:91], v[44:47], v[252:255], v[88:91]
    ds_read_b64_tr_b16 v[34:35], v11 offset:21248
    s_add_u32 s53, s54, 3
    s_and_b32 s53, s53, 7
    s_add_u32 m0, s95, 28672
    s_mul_i32 s7, s53, 176128
    buffer_load_dwordx4 v6, s[16:19], s7 offen offset:0 lds
    v_mfma_f32_16x16x32_bf16 v[92:95], v[48:51], v[248:251], v[92:95]
    ds_read_b64_tr_b16 v[36:37], v12 offset:20512
    v_mfma_f32_16x16x32_bf16 v[96:99], v[48:51], v[252:255], v[96:99]
    ds_read_b64_tr_b16 v[38:39], v12 offset:21280
    s_waitcnt lgkmcnt(10)
    ds_read_b64_tr_b16 v[40:41], v11 offset:20544
    ds_read_b64_tr_b16 v[42:43], v11 offset:21312
    s_waitcnt lgkmcnt(10)
    v_mul_f32 v20, s0, v25
    v_mul_f32 v22, s0, v27
    v_pk_add_f32 v[100:101], v[100:101], v[120:121]
    v_pk_add_f32 v[102:103], v[102:103], v[122:123]
    v_pk_add_f32 v[104:105], v[104:105], v[124:125]
    v_pk_add_f32 v[106:107], v[106:107], v[126:127]
    v_pk_add_f32 v[108:109], v[108:109], v[52:53]
    v_pk_add_f32 v[110:111], v[110:111], v[54:55]
    v_pk_add_f32 v[112:113], v[112:113], v[28:29]
    v_pk_add_f32 v[114:115], v[114:115], v[30:31]
    v_pk_fma_f32 v[68:69], v[100:101], v[24:25], v[68:69] op_sel_hi:[1,0,1]
    v_pk_fma_f32 v[70:71], v[102:103], v[24:25], v[70:71] op_sel_hi:[1,0,1]
    v_pk_mul_f32 v[68:69], v[68:69], v[20:21] op_sel_hi:[1,0]
    v_pk_mul_f32 v[70:71], v[70:71], v[20:21] op_sel_hi:[1,0]
    v_pk_fma_f32 v[72:73], v[100:101], v[26:27], v[72:73] op_sel_hi:[1,0,1]
    v_pk_fma_f32 v[74:75], v[102:103], v[26:27], v[74:75] op_sel_hi:[1,0,1]
    v_pk_mul_f32 v[72:73], v[72:73], v[22:23] op_sel_hi:[1,0]
    v_pk_mul_f32 v[74:75], v[74:75], v[22:23] op_sel_hi:[1,0]
    v_cvt_pk_bf16_f32 v120, v68, v69
    v_cvt_pk_bf16_f32 v121, v70, v71
    v_cvt_pk_bf16_f32 v122, v72, v73
    v_cvt_pk_bf16_f32 v123, v74, v75
    s_nop 1
    v_permlane16_swap_b32 v120, v122
    v_permlane16_swap_b32 v121, v123
    buffer_store_dwordx4 v[120:123], v17, s[20:23], s80 offen sc1
    v_pk_fma_f32 v[76:77], v[104:105], v[24:25], v[76:77] op_sel_hi:[1,0,1]
    v_pk_fma_f32 v[78:79], v[106:107], v[24:25], v[78:79] op_sel_hi:[1,0,1]
    v_pk_mul_f32 v[76:77], v[76:77], v[20:21] op_sel_hi:[1,0]
    v_pk_mul_f32 v[78:79], v[78:79], v[20:21] op_sel_hi:[1,0]
    v_pk_fma_f32 v[80:81], v[104:105], v[26:27], v[80:81] op_sel_hi:[1,0,1]
    v_pk_fma_f32 v[82:83], v[106:107], v[26:27], v[82:83] op_sel_hi:[1,0,1]
    v_pk_mul_f32 v[80:81], v[80:81], v[22:23] op_sel_hi:[1,0]
    v_pk_mul_f32 v[82:83], v[82:83], v[22:23] op_sel_hi:[1,0]
    v_cvt_pk_bf16_f32 v124, v76, v77
    v_cvt_pk_bf16_f32 v125, v78, v79
    v_cvt_pk_bf16_f32 v126, v80, v81
    v_cvt_pk_bf16_f32 v127, v82, v83
    s_nop 1
    v_permlane16_swap_b32 v124, v126
    v_permlane16_swap_b32 v125, v127
    buffer_store_dwordx4 v[124:127], v17, s[20:23], s81 offen sc1
    v_pk_fma_f32 v[84:85], v[108:109], v[24:25], v[84:85] op_sel_hi:[1,0,1]
    v_pk_fma_f32 v[86:87], v[110:111], v[24:25], v[86:87] op_sel_hi:[1,0,1]
    v_pk_mul_f32 v[84:85], v[84:85], v[20:21] op_sel_hi:[1,0]
    v_pk_mul_f32 v[86:87], v[86:87], v[20:21] op_sel_hi:[1,0]
    v_pk_fma_f32 v[88:89], v[108:109], v[26:27], v[88:89] op_sel_hi:[1,0,1]
    v_pk_fma_f32 v[90:91], v[110:111], v[26:27], v[90:91] op_sel_hi:[1,0,1]
    v_pk_mul_f32 v[88:89], v[88:89], v[22:23] op_sel_hi:[1,0]
    v_pk_mul_f32 v[90:91], v[90:91], v[22:23] op_sel_hi:[1,0]
    v_cvt_pk_bf16_f32 v44, v84, v85
    v_cvt_pk_bf16_f32 v45, v86, v87
    v_cvt_pk_bf16_f32 v46, v88, v89
    v_cvt_pk_bf16_f32 v47, v90, v91
    s_nop 1
    v_permlane16_swap_b32 v44, v46
    v_permlane16_swap_b32 v45, v47
    buffer_store_dwordx4 v[44:47], v17, s[20:23], s82 offen sc1
    v_pk_fma_f32 v[92:93], v[112:113], v[24:25], v[92:93] op_sel_hi:[1,0,1]
    v_pk_fma_f32 v[94:95], v[114:115], v[24:25], v[94:95] op_sel_hi:[1,0,1]
    v_pk_mul_f32 v[92:93], v[92:93], v[20:21] op_sel_hi:[1,0]
    v_pk_mul_f32 v[94:95], v[94:95], v[20:21] op_sel_hi:[1,0]
    v_pk_fma_f32 v[96:97], v[112:113], v[26:27], v[96:97] op_sel_hi:[1,0,1]
    v_pk_fma_f32 v[98:99], v[114:115], v[26:27], v[98:99] op_sel_hi:[1,0,1]
    v_pk_mul_f32 v[96:97], v[96:97], v[22:23] op_sel_hi:[1,0]
    v_pk_mul_f32 v[98:99], v[98:99], v[22:23] op_sel_hi:[1,0]
    v_cvt_pk_bf16_f32 v48, v92, v93
    v_cvt_pk_bf16_f32 v49, v94, v95
    v_cvt_pk_bf16_f32 v50, v96, v97
    v_cvt_pk_bf16_f32 v51, v98, v99
    s_nop 1
    v_permlane16_swap_b32 v48, v50
    v_permlane16_swap_b32 v49, v51
    buffer_store_dwordx4 v[48:51], v17, s[20:23], s83 offen sc1
    v_lshrrev_b32 v16, 5, v1
    v_bfe_u32 v124, v1, 1, 1
    v_cmp_eq_u32 vcc, v16, v124
    v_mov_b32 v127, s39
    v_and_b32 v16, 1, v1
    v_cndmask_b32 v124, 0, v127, vcc
    v_cndmask_b32 v125, 0, v127, vcc
    v_cndmask_b32 v126, 0, v127, vcc
    v_cndmask_b32 v127, 0, v127, vcc
    v_mul_u32_u24 v16, 0xaaaa, v16
    v_add_u32 v16, 0x4444, v16
    v_mov_b32 v120, 0
    v_mov_b32 v121, 0
    v_mov_b32 v122, 0
    v_mov_b32 v123, 0
    s_waitcnt lgkmcnt(6)
    v_mfma_f32_16x16x32_bf16 v[68:71], v[56:59], v[128:131], 0
    ds_read_b64_tr_b16 v[44:45], v13 offset:20480
    v_mfma_f32_16x16x32_bf16 v[72:75], v[56:59], v[132:135], 0
    ds_read_b64_tr_b16 v[46:47], v13 offset:21248
    buffer_load_dwordx4 v7, s[16:19], s7 offen offset:1024 lds
    v_mfma_f32_16x16x32_bf16 v[76:79], v[60:63], v[128:131], 0
    ds_read_b64_tr_b16 v[48:49], v14 offset:20512
    v_mfma_f32_16x16x32_bf16 v[80:83], v[60:63], v[132:135], 0
    ds_read_b64_tr_b16 v[50:51], v14 offset:21280
    v_mfma_f32_16x16x32_bf16 v[84:87], v[64:67], v[128:131], 0
    ds_read_b64_tr_b16 v[52:53], v13 offset:20544
    v_mfma_f32_16x16x32_bf16 v[88:91], v[64:67], v[132:135], 0
    ds_read_b64_tr_b16 v[54:55], v13 offset:21312
    v_smfmac_f32_16x16x64_bf16 v[120:123], v[124:127], v[56:63], v16
    v_mfma_f32_16x16x32_bf16 v[28:31], v[116:119], v[64:67], 0
    s_waitcnt lgkmcnt(6)
    v_mfma_f32_16x16x32_bf16 v[92:95], v[32:35], v[128:131], 0
    ds_read_b64_tr_b16 v[56:57], v15 offset:20480
    v_mfma_f32_16x16x32_bf16 v[96:99], v[32:35], v[132:135], 0
    ds_read_b64_tr_b16 v[58:59], v15 offset:21248
    buffer_load_dwordx4 v8, s[16:19], s7 offen offset:2048 lds
    v_mfma_f32_16x16x32_bf16 v[100:103], v[36:39], v[128:131], 0
    ds_read_b64_tr_b16 v[60:61], v21 offset:20512
    v_mfma_f32_16x16x32_bf16 v[104:107], v[36:39], v[132:135], 0
    ds_read_b64_tr_b16 v[62:63], v21 offset:21280
    v_mfma_f32_16x16x32_bf16 v[108:111], v[40:43], v[128:131], 0
    ds_read_b64_tr_b16 v[64:65], v15 offset:20544
    v_mfma_f32_16x16x32_bf16 v[112:115], v[40:43], v[132:135], 0
    ds_read_b64_tr_b16 v[66:67], v15 offset:21312
    s_waitcnt vmcnt(10)
    s_barrier
    s_waitcnt lgkmcnt(6)
    v_mfma_f32_16x16x32_bf16 v[68:71], v[44:47], v[136:139], v[68:71]
    ds_read_b64_tr_b16 v[32:33], v9 offset:49152
    v_mfma_f32_16x16x32_bf16 v[72:75], v[44:47], v[140:143], v[72:75]
    ds_read_b64_tr_b16 v[34:35], v9 offset:49920
    s_add_u32 s53, s54, 4
    s_and_b32 s53, s53, 7
    s_add_u32 m0, s95, 57344
    s_mul_i32 s7, s53, 176128
    buffer_load_dwordx4 v6, s[16:19], s7 offen offset:0 lds
    v_mfma_f32_16x16x32_bf16 v[76:79], v[48:51], v[136:139], v[76:79]
    ds_read_b64_tr_b16 v[36:37], v10 offset:49184
    v_mfma_f32_16x16x32_bf16 v[80:83], v[48:51], v[140:143], v[80:83]
    ds_read_b64_tr_b16 v[38:39], v10 offset:49952
    v_mfma_f32_16x16x32_bf16 v[84:87], v[52:55], v[136:139], v[84:87]
    ds_read_b64_tr_b16 v[40:41], v9 offset:49216
    v_mfma_f32_16x16x32_bf16 v[88:91], v[52:55], v[140:143], v[88:91]
    ds_read_b64_tr_b16 v[42:43], v9 offset:49984
    s_waitcnt lgkmcnt(6)
    v_mfma_f32_16x16x32_bf16 v[92:95], v[56:59], v[136:139], v[92:95]
    ds_read_b64_tr_b16 v[44:45], v11 offset:49152
    v_mfma_f32_16x16x32_bf16 v[96:99], v[56:59], v[140:143], v[96:99]
    ds_read_b64_tr_b16 v[46:47], v11 offset:49920
    buffer_load_dwordx4 v7, s[16:19], s7 offen offset:1024 lds
    v_mfma_f32_16x16x32_bf16 v[100:103], v[60:63], v[136:139], v[100:103]
    ds_read_b64_tr_b16 v[48:49], v12 offset:49184
    v_mfma_f32_16x16x32_bf16 v[104:107], v[60:63], v[140:143], v[104:107]
    ds_read_b64_tr_b16 v[50:51], v12 offset:49952
    v_and_b32 v19, 27, v1
    v_cmp_eq_u32 vcc, 16, v19
    v_mov_b32 v22, s39
    s_nop 0
    v_cndmask_b32 v19, 0, v22, vcc
    v_cndmask_b32 v18, 0, v22, vcc
    v_mfma_f32_16x16x32_bf16 v[108:111], v[64:67], v[136:139], v[108:111]
    ds_read_b64_tr_b16 v[52:53], v11 offset:49216
    v_mfma_f32_16x16x32_bf16 v[112:115], v[64:67], v[140:143], v[112:115]
    ds_read_b64_tr_b16 v[54:55], v11 offset:49984
    s_waitcnt lgkmcnt(6)
    v_mfma_f32_16x16x32_bf16 v[68:71], v[32:35], v[144:147], v[68:71]
    ds_read_b64_tr_b16 v[56:57], v13 offset:49152
    v_mfma_f32_16x16x32_bf16 v[72:75], v[32:35], v[148:151], v[72:75]
    ds_read_b64_tr_b16 v[58:59], v13 offset:49920
    buffer_load_dwordx4 v8, s[16:19], s7 offen offset:2048 lds
    v_mfma_f32_16x16x32_bf16 v[76:79], v[36:39], v[144:147], v[76:79]
    ds_read_b64_tr_b16 v[60:61], v14 offset:49184
    v_mfma_f32_16x16x32_bf16 v[80:83], v[36:39], v[148:151], v[80:83]
    ds_read_b64_tr_b16 v[62:63], v14 offset:49952
    v_mov_b64 v[128:129], v[18:19]
    v_mfma_f32_16x16x32_bf16 v[84:87], v[40:43], v[144:147], v[84:87]
    ds_read_b64_tr_b16 v[64:65], v13 offset:49216
    v_mfma_f32_16x16x32_bf16 v[88:91], v[40:43], v[148:151], v[88:91]
    ds_read_b64_tr_b16 v[66:67], v13 offset:49984
    v_mov_b64 v[130:131], v[18:19]
    v_smfmac_f32_16x16x64_bf16 v[120:123], v[124:127], v[32:39], v16
    v_mfma_f32_16x16x32_bf16 v[28:31], v[116:119], v[40:43], v[28:31]
    s_waitcnt lgkmcnt(6)
    v_mfma_f32_16x16x32_bf16 v[92:95], v[44:47], v[144:147], v[92:95]
    ds_read_b64_tr_b16 v[32:33], v15 offset:49152
    v_mfma_f32_16x16x32_bf16 v[96:99], v[44:47], v[148:151], v[96:99]
    ds_read_b64_tr_b16 v[34:35], v15 offset:49920
    v_mov_b64 v[132:133], v[18:19]
    v_mfma_f32_16x16x32_bf16 v[100:103], v[48:51], v[144:147], v[100:103]
    ds_read_b64_tr_b16 v[36:37], v21 offset:49184
    v_mfma_f32_16x16x32_bf16 v[104:107], v[48:51], v[148:151], v[104:107]
    ds_read_b64_tr_b16 v[38:39], v21 offset:49952
    v_mov_b64 v[134:135], v[18:19]
    v_mfma_f32_16x16x32_bf16 v[108:111], v[52:55], v[144:147], v[108:111]
    ds_read_b64_tr_b16 v[40:41], v15 offset:49216
    v_mfma_f32_16x16x32_bf16 v[112:115], v[52:55], v[148:151], v[112:115]
    ds_read_b64_tr_b16 v[42:43], v15 offset:49984
    s_waitcnt vmcnt(10)
    s_barrier
    s_waitcnt lgkmcnt(6)
    v_add_u32 v9, 0xffff0000, v9
    v_add_u32 v10, 0xffff0000, v10
    v_mfma_f32_16x16x32_bf16 v[68:71], v[56:59], v[152:155], v[68:71]
    ds_read_b64_tr_b16 v[44:45], v9 offset:0
    v_mfma_f32_16x16x32_bf16 v[72:75], v[56:59], v[156:159], v[72:75]
    ds_read_b64_tr_b16 v[46:47], v9 offset:768
    s_add_u32 s53, s54, 5
    s_and_b32 s53, s53, 7
    s_add_u32 m0, s95, 86016
    s_mul_i32 s7, s53, 176128
    buffer_load_dwordx4 v6, s[16:19], s7 offen offset:0 lds
    v_mfma_f32_16x16x32_bf16 v[76:79], v[60:63], v[152:155], v[76:79]
    ds_read_b64_tr_b16 v[48:49], v10 offset:32
    v_mfma_f32_16x16x32_bf16 v[80:83], v[60:63], v[156:159], v[80:83]
    ds_read_b64_tr_b16 v[50:51], v10 offset:800
    v_mov_b64 v[136:137], v[18:19]
    v_mfma_f32_16x16x32_bf16 v[84:87], v[64:67], v[152:155], v[84:87]
    ds_read_b64_tr_b16 v[52:53], v9 offset:64
    v_mfma_f32_16x16x32_bf16 v[88:91], v[64:67], v[156:159], v[88:91]
    ds_read_b64_tr_b16 v[54:55], v9 offset:832
    v_mov_b64 v[138:139], v[18:19]
    s_waitcnt lgkmcnt(6)
    v_add_u32 v11, 0xffff0000, v11
    v_add_u32 v12, 0xffff0000, v12
    v_mfma_f32_16x16x32_bf16 v[92:95], v[32:35], v[152:155], v[92:95]
    ds_read_b64_tr_b16 v[56:57], v11 offset:0
    v_mfma_f32_16x16x32_bf16 v[96:99], v[32:35], v[156:159], v[96:99]
    ds_read_b64_tr_b16 v[58:59], v11 offset:768
    buffer_load_dwordx4 v7, s[16:19], s7 offen offset:1024 lds
    v_mfma_f32_16x16x32_bf16 v[100:103], v[36:39], v[152:155], v[100:103]
    ds_read_b64_tr_b16 v[60:61], v12 offset:32
    v_mfma_f32_16x16x32_bf16 v[104:107], v[36:39], v[156:159], v[104:107]
    ds_read_b64_tr_b16 v[62:63], v12 offset:800
    v_mov_b64 v[140:141], v[18:19]
    v_mfma_f32_16x16x32_bf16 v[108:111], v[40:43], v[152:155], v[108:111]
    ds_read_b64_tr_b16 v[64:65], v11 offset:64
    v_mfma_f32_16x16x32_bf16 v[112:115], v[40:43], v[156:159], v[112:115]
    ds_read_b64_tr_b16 v[66:67], v11 offset:832
    v_mov_b64 v[142:143], v[18:19]
    s_waitcnt lgkmcnt(6)
    v_add_u32 v13, 0xffff0000, v13
    v_add_u32 v14, 0xffff0000, v14
    v_mfma_f32_16x16x32_bf16 v[68:71], v[44:47], v[160:163], v[68:71]
    ds_read_b64_tr_b16 v[32:33], v13 offset:0
    v_mfma_f32_16x16x32_bf16 v[72:75], v[44:47], v[164:167], v[72:75]
    ds_read_b64_tr_b16 v[34:35], v13 offset:768
    buffer_load_dwordx4 v8, s[16:19], s7 offen offset:2048 lds
    v_mfma_f32_16x16x32_bf16 v[76:79], v[48:51], v[160:163], v[76:79]
    ds_read_b64_tr_b16 v[36:37], v14 offset:32
    v_mfma_f32_16x16x32_bf16 v[80:83], v[48:51], v[164:167], v[80:83]
    ds_read_b64_tr_b16 v[38:39], v14 offset:800
    v_mov_b64 v[144:145], v[18:19]
    v_mfma_f32_16x16x32_bf16 v[84:87], v[52:55], v[160:163], v[84:87]
    ds_read_b64_tr_b16 v[40:41], v13 offset:64
    v_mfma_f32_16x16x32_bf16 v[88:91], v[52:55], v[164:167], v[88:91]
    ds_read_b64_tr_b16 v[42:43], v13 offset:832
    v_mov_b64 v[146:147], v[18:19]
    v_smfmac_f32_16x16x64_bf16 v[120:123], v[124:127], v[44:51], v16
    v_mfma_f32_16x16x32_bf16 v[28:31], v[116:119], v[52:55], v[28:31]
    s_waitcnt lgkmcnt(6)
    v_add_u32 v15, 0xffff0000, v15
    v_add_u32 v21, 0xffff0000, v21
    v_mfma_f32_16x16x32_bf16 v[92:95], v[56:59], v[160:163], v[92:95]
    ds_read_b64_tr_b16 v[44:45], v15 offset:0
    v_mfma_f32_16x16x32_bf16 v[96:99], v[56:59], v[164:167], v[96:99]
    ds_read_b64_tr_b16 v[46:47], v15 offset:768
    v_mov_b64 v[148:149], v[18:19]
    v_mfma_f32_16x16x32_bf16 v[100:103], v[60:63], v[160:163], v[100:103]
    ds_read_b64_tr_b16 v[48:49], v21 offset:32
    v_mfma_f32_16x16x32_bf16 v[104:107], v[60:63], v[164:167], v[104:107]
    ds_read_b64_tr_b16 v[50:51], v21 offset:800
    v_mov_b64 v[150:151], v[18:19]
    v_mfma_f32_16x16x32_bf16 v[108:111], v[64:67], v[160:163], v[108:111]
    ds_read_b64_tr_b16 v[52:53], v15 offset:64
    v_mfma_f32_16x16x32_bf16 v[112:115], v[64:67], v[164:167], v[112:115]
    ds_read_b64_tr_b16 v[54:55], v15 offset:832
    s_waitcnt vmcnt(6)
    s_barrier
    s_lshl_b32 s48, s43, 4
    s_add_u32 s48, s48, s42
    s_lshl_b32 s48, s48, 8
    s_add_u32 s51, s48, 14680064
    s_cmp_lg_u32 s36, 0
    s_cbranch_scc1 L_sig_4
    v_mov_b32 v17, s3
    s_mov_b32 exec_hi, 0
    v_lshlrev_b32 v20, 2, v1
    buffer_store_dword v17, v20, s[20:23], s51 offen sc1
    s_mov_b64 exec, -1
L_sig_4:
    s_waitcnt lgkmcnt(6)
    v_mfma_f32_16x16x32_bf16 v[68:71], v[32:35], v[168:171], v[68:71]
    ds_read_b64_tr_b16 v[56:57], v9 offset:28672
    v_mfma_f32_16x16x32_bf16 v[72:75], v[32:35], v[172:175], v[72:75]
    ds_read_b64_tr_b16 v[58:59], v9 offset:29440
    s_add_u32 s53, s54, 6
    s_and_b32 s53, s53, 7
    s_add_u32 m0, s95, 114688
    s_mul_i32 s7, s53, 176128
    buffer_load_dwordx4 v6, s[16:19], s7 offen offset:0 lds
    v_mfma_f32_16x16x32_bf16 v[76:79], v[36:39], v[168:171], v[76:79]
    ds_read_b64_tr_b16 v[60:61], v10 offset:28704
    v_mfma_f32_16x16x32_bf16 v[80:83], v[36:39], v[172:175], v[80:83]
    ds_read_b64_tr_b16 v[62:63], v10 offset:29472
    v_mov_b64 v[152:153], v[18:19]
    v_mfma_f32_16x16x32_bf16 v[84:87], v[40:43], v[168:171], v[84:87]
    ds_read_b64_tr_b16 v[64:65], v9 offset:28736
    v_mfma_f32_16x16x32_bf16 v[88:91], v[40:43], v[172:175], v[88:91]
    ds_read_b64_tr_b16 v[66:67], v9 offset:29504
    v_mov_b64 v[154:155], v[18:19]
    s_waitcnt lgkmcnt(6)
    v_mfma_f32_16x16x32_bf16 v[92:95], v[44:47], v[168:171], v[92:95]
    ds_read_b64_tr_b16 v[32:33], v11 offset:28672
    v_mfma_f32_16x16x32_bf16 v[96:99], v[44:47], v[172:175], v[96:99]
    ds_read_b64_tr_b16 v[34:35], v11 offset:29440
    buffer_load_dwordx4 v7, s[16:19], s7 offen offset:1024 lds
    v_mfma_f32_16x16x32_bf16 v[100:103], v[48:51], v[168:171], v[100:103]
    ds_read_b64_tr_b16 v[36:37], v12 offset:28704
    v_mfma_f32_16x16x32_bf16 v[104:107], v[48:51], v[172:175], v[104:107]
    ds_read_b64_tr_b16 v[38:39], v12 offset:29472
    v_mov_b64 v[156:157], v[18:19]
    v_mfma_f32_16x16x32_bf16 v[108:111], v[52:55], v[168:171], v[108:111]
    ds_read_b64_tr_b16 v[40:41], v11 offset:28736
    v_mfma_f32_16x16x32_bf16 v[112:115], v[52:55], v[172:175], v[112:115]
    ds_read_b64_tr_b16 v[42:43], v11 offset:29504
    v_mov_b64 v[158:159], v[18:19]
    s_waitcnt lgkmcnt(6)
    v_mfma_f32_16x16x32_bf16 v[68:71], v[56:59], v[176:179], v[68:71]
    ds_read_b64_tr_b16 v[44:45], v13 offset:28672
    v_mfma_f32_16x16x32_bf16 v[72:75], v[56:59], v[180:183], v[72:75]
    ds_read_b64_tr_b16 v[46:47], v13 offset:29440
    buffer_load_dwordx4 v8, s[16:19], s7 offen offset:2048 lds
    v_mfma_f32_16x16x32_bf16 v[76:79], v[60:63], v[176:179], v[76:79]
    ds_read_b64_tr_b16 v[48:49], v14 offset:28704
    v_mfma_f32_16x16x32_bf16 v[80:83], v[60:63], v[180:183], v[80:83]
    ds_read_b64_tr_b16 v[50:51], v14 offset:29472
    v_mov_b64 v[160:161], v[18:19]
    v_mfma_f32_16x16x32_bf16 v[84:87], v[64:67], v[176:179], v[84:87]
    ds_read_b64_tr_b16 v[52:53], v13 offset:28736
    v_mfma_f32_16x16x32_bf16 v[88:91], v[64:67], v[180:183], v[88:91]
    ds_read_b64_tr_b16 v[54:55], v13 offset:29504
    v_mov_b64 v[162:163], v[18:19]
    v_smfmac_f32_16x16x64_bf16 v[120:123], v[124:127], v[56:63], v16
    v_mfma_f32_16x16x32_bf16 v[28:31], v[116:119], v[64:67], v[28:31]
    s_waitcnt lgkmcnt(6)
    v_mfma_f32_16x16x32_bf16 v[92:95], v[32:35], v[176:179], v[92:95]
    ds_read_b64_tr_b16 v[56:57], v15 offset:28672
    v_mfma_f32_16x16x32_bf16 v[96:99], v[32:35], v[180:183], v[96:99]
    ds_read_b64_tr_b16 v[58:59], v15 offset:29440
    v_mov_b64 v[164:165], v[18:19]
    v_mfma_f32_16x16x32_bf16 v[100:103], v[36:39], v[176:179], v[100:103]
    ds_read_b64_tr_b16 v[60:61], v21 offset:28704
    v_mfma_f32_16x16x32_bf16 v[104:107], v[36:39], v[180:183], v[104:107]
    ds_read_b64_tr_b16 v[62:63], v21 offset:29472
    v_mov_b64 v[166:167], v[18:19]
    v_mfma_f32_16x16x32_bf16 v[108:111], v[40:43], v[176:179], v[108:111]
    ds_read_b64_tr_b16 v[64:65], v15 offset:28736
    v_mfma_f32_16x16x32_bf16 v[112:115], v[40:43], v[180:183], v[112:115]
    ds_read_b64_tr_b16 v[66:67], v15 offset:29504
    s_waitcnt vmcnt(6)
    s_barrier
    s_waitcnt lgkmcnt(6)
    v_mfma_f32_16x16x32_bf16 v[68:71], v[44:47], v[184:187], v[68:71]
    ds_read_b64_tr_b16 v[32:33], v9 offset:57344
    v_mfma_f32_16x16x32_bf16 v[72:75], v[44:47], v[188:191], v[72:75]
    ds_read_b64_tr_b16 v[34:35], v9 offset:58112
    s_add_u32 s53, s54, 7
    s_and_b32 s53, s53, 7
    s_add_u32 m0, s95, 0
    s_mul_i32 s7, s53, 176128
    buffer_load_dwordx4 v6, s[16:19], s7 offen offset:0 lds
    v_mfma_f32_16x16x32_bf16 v[76:79], v[48:51], v[184:187], v[76:79]
    ds_read_b64_tr_b16 v[36:37], v10 offset:57376
    v_mfma_f32_16x16x32_bf16 v[80:83], v[48:51], v[188:191], v[80:83]
    ds_read_b64_tr_b16 v[38:39], v10 offset:58144
    v_lshlrev_b32 v2, 4, v1
    v_and_b32 v3, 15, v1
    v_lshlrev_b32 v3, 4, v3
    v_lshrrev_b32 v22, 5, v1
    v_lshl_add_u32 v3, v22, 8, v3
    v_mfma_f32_16x16x32_bf16 v[84:87], v[52:55], v[184:187], v[84:87]
    ds_read_b64_tr_b16 v[40:41], v9 offset:57408
    v_mfma_f32_16x16x32_bf16 v[88:91], v[52:55], v[188:191], v[88:91]
    ds_read_b64_tr_b16 v[42:43], v9 offset:58176
    v_mov_b64 v[168:169], v[18:19]
    v_mov_b64 v[170:171], v[18:19]
    s_waitcnt lgkmcnt(6)
    v_mfma_f32_16x16x32_bf16 v[92:95], v[56:59], v[184:187], v[92:95]
    ds_read_b64_tr_b16 v[44:45], v11 offset:57344
    v_mfma_f32_16x16x32_bf16 v[96:99], v[56:59], v[188:191], v[96:99]
    ds_read_b64_tr_b16 v[46:47], v11 offset:58112
    buffer_load_dwordx4 v7, s[16:19], s7 offen offset:1024 lds
    v_mfma_f32_16x16x32_bf16 v[100:103], v[60:63], v[184:187], v[100:103]
    ds_read_b64_tr_b16 v[48:49], v12 offset:57376
    v_mfma_f32_16x16x32_bf16 v[104:107], v[60:63], v[188:191], v[104:107]
    ds_read_b64_tr_b16 v[50:51], v12 offset:58144
    v_mov_b64 v[172:173], v[18:19]
    v_mfma_f32_16x16x32_bf16 v[108:111], v[64:67], v[184:187], v[108:111]
    ds_read_b64_tr_b16 v[52:53], v11 offset:57408
    v_mfma_f32_16x16x32_bf16 v[112:115], v[64:67], v[188:191], v[112:115]
    ds_read_b64_tr_b16 v[54:55], v11 offset:58176
    v_mov_b64 v[174:175], v[18:19]
    s_waitcnt lgkmcnt(6)
    v_mfma_f32_16x16x32_bf16 v[68:71], v[32:35], v[192:195], v[68:71]
    ds_read_b64_tr_b16 v[56:57], v13 offset:57344
    v_mfma_f32_16x16x32_bf16 v[72:75], v[32:35], v[196:199], v[72:75]
    ds_read_b64_tr_b16 v[58:59], v13 offset:58112
    buffer_load_dwordx4 v8, s[16:19], s7 offen offset:2048 lds
    v_mfma_f32_16x16x32_bf16 v[76:79], v[36:39], v[192:195], v[76:79]
    ds_read_b64_tr_b16 v[60:61], v14 offset:57376
    v_mfma_f32_16x16x32_bf16 v[80:83], v[36:39], v[196:199], v[80:83]
    ds_read_b64_tr_b16 v[62:63], v14 offset:58144
    v_mov_b64 v[176:177], v[18:19]
    v_mfma_f32_16x16x32_bf16 v[84:87], v[40:43], v[192:195], v[84:87]
    ds_read_b64_tr_b16 v[64:65], v13 offset:57408
    v_mfma_f32_16x16x32_bf16 v[88:91], v[40:43], v[196:199], v[88:91]
    ds_read_b64_tr_b16 v[66:67], v13 offset:58176
    v_mov_b64 v[178:179], v[18:19]
    v_smfmac_f32_16x16x64_bf16 v[120:123], v[124:127], v[32:39], v16
    v_mfma_f32_16x16x32_bf16 v[28:31], v[116:119], v[40:43], v[28:31]
    s_waitcnt lgkmcnt(6)
    v_mfma_f32_16x16x32_bf16 v[92:95], v[44:47], v[192:195], v[92:95]
    ds_read_b64_tr_b16 v[32:33], v15 offset:57344
    v_mfma_f32_16x16x32_bf16 v[96:99], v[44:47], v[196:199], v[96:99]
    ds_read_b64_tr_b16 v[34:35], v15 offset:58112
    v_mov_b64 v[180:181], v[18:19]
    v_mfma_f32_16x16x32_bf16 v[100:103], v[48:51], v[192:195], v[100:103]
    ds_read_b64_tr_b16 v[36:37], v21 offset:57376
    v_mfma_f32_16x16x32_bf16 v[104:107], v[48:51], v[196:199], v[104:107]
    ds_read_b64_tr_b16 v[38:39], v21 offset:58144
    v_mov_b64 v[182:183], v[18:19]
    v_mfma_f32_16x16x32_bf16 v[108:111], v[52:55], v[192:195], v[108:111]
    ds_read_b64_tr_b16 v[40:41], v15 offset:57408
    v_mfma_f32_16x16x32_bf16 v[112:115], v[52:55], v[196:199], v[112:115]
    ds_read_b64_tr_b16 v[42:43], v15 offset:58176
    s_waitcnt vmcnt(6)
    s_barrier
    s_waitcnt lgkmcnt(6)
    v_add_u32 v9, 0x10000, v9
    v_add_u32 v10, 0x10000, v10
    v_mfma_f32_16x16x32_bf16 v[68:71], v[56:59], v[200:203], v[68:71]
    ds_read_b64_tr_b16 v[44:45], v9 offset:20480
    v_mfma_f32_16x16x32_bf16 v[72:75], v[56:59], v[204:207], v[72:75]
    ds_read_b64_tr_b16 v[46:47], v9 offset:21248
    v_mov_b64 v[184:185], v[18:19]
    v_mfma_f32_16x16x32_bf16 v[76:79], v[60:63], v[200:203], v[76:79]
    ds_read_b64_tr_b16 v[48:49], v10 offset:20512
    v_mfma_f32_16x16x32_bf16 v[80:83], v[60:63], v[204:207], v[80:83]
    ds_read_b64_tr_b16 v[50:51], v10 offset:21280
    v_mov_b64 v[186:187], v[18:19]
    v_mfma_f32_16x16x32_bf16 v[84:87], v[64:67], v[200:203], v[84:87]
    ds_read_b64_tr_b16 v[52:53], v9 offset:20544
    v_mfma_f32_16x16x32_bf16 v[88:91], v[64:67], v[204:207], v[88:91]
    ds_read_b64_tr_b16 v[54:55], v9 offset:21312
    s_mov_b64 exec, 0x3f
    buffer_load_dword v5, v0, s[20:23], 0 offen sc1
    s_mov_b64 exec, -1
    s_waitcnt lgkmcnt(6)
    v_add_u32 v11, 0x10000, v11
    v_add_u32 v12, 0x10000, v12
    v_mfma_f32_16x16x32_bf16 v[92:95], v[32:35], v[200:203], v[92:95]
    ds_read_b64_tr_b16 v[56:57], v11 offset:20480
    v_mfma_f32_16x16x32_bf16 v[96:99], v[32:35], v[204:207], v[96:99]
    ds_read_b64_tr_b16 v[58:59], v11 offset:21248
    v_mov_b64 v[188:189], v[18:19]
    v_mfma_f32_16x16x32_bf16 v[100:103], v[36:39], v[200:203], v[100:103]
    ds_read_b64_tr_b16 v[60:61], v12 offset:20512
    v_mfma_f32_16x16x32_bf16 v[104:107], v[36:39], v[204:207], v[104:107]
    ds_read_b64_tr_b16 v[62:63], v12 offset:21280
    v_mov_b64 v[190:191], v[18:19]
    v_mfma_f32_16x16x32_bf16 v[108:111], v[40:43], v[200:203], v[108:111]
    ds_read_b64_tr_b16 v[64:65], v11 offset:20544
    v_mfma_f32_16x16x32_bf16 v[112:115], v[40:43], v[204:207], v[112:115]
    ds_read_b64_tr_b16 v[66:67], v11 offset:21312
    s_waitcnt lgkmcnt(6)
    v_add_u32 v13, 0x10000, v13
    v_add_u32 v14, 0x10000, v14
    v_mfma_f32_16x16x32_bf16 v[68:71], v[44:47], v[208:211], v[68:71]
    ds_read_b64_tr_b16 v[32:33], v13 offset:20480
    v_mfma_f32_16x16x32_bf16 v[72:75], v[44:47], v[212:215], v[72:75]
    ds_read_b64_tr_b16 v[34:35], v13 offset:21248
    v_mfma_f32_16x16x32_bf16 v[76:79], v[48:51], v[208:211], v[76:79]
    ds_read_b64_tr_b16 v[36:37], v14 offset:20512
    v_mfma_f32_16x16x32_bf16 v[80:83], v[48:51], v[212:215], v[80:83]
    ds_read_b64_tr_b16 v[38:39], v14 offset:21280
    v_mfma_f32_16x16x32_bf16 v[84:87], v[52:55], v[208:211], v[84:87]
    ds_read_b64_tr_b16 v[40:41], v13 offset:20544
    v_mfma_f32_16x16x32_bf16 v[88:91], v[52:55], v[212:215], v[88:91]
    ds_read_b64_tr_b16 v[42:43], v13 offset:21312
    v_smfmac_f32_16x16x64_bf16 v[120:123], v[124:127], v[44:51], v16
    v_mfma_f32_16x16x32_bf16 v[28:31], v[116:119], v[52:55], v[28:31]
    s_waitcnt vmcnt(0)
    s_mov_b64 exec, 0x3f
    v_cmp_ne_u32 vcc, s3, v5
    s_mov_b32 s79, 20000
    s_cbranch_vccz L_pok_5
L_psp_6:
    s_sleep 8
    buffer_load_dword v5, v0, s[20:23], 0 offen sc1
    s_sub_u32 s79, s79, 1
    s_waitcnt vmcnt(0)
    v_cmp_ne_u32 vcc, s3, v5
    s_cmp_eq_u32 s79, 0
    s_cbranch_scc1 L_pok_5
    s_cbranch_vccnz L_psp_6
L_pok_5:
    s_mov_b64 exec, -1
    s_waitcnt lgkmcnt(6)
    v_add_u32 v15, 0x10000, v15
    v_add_u32 v21, 0x10000, v21
    v_mfma_f32_16x16x32_bf16 v[92:95], v[56:59], v[208:211], v[92:95]
    ds_read_b64_tr_b16 v[44:45], v15 offset:20480
    v_mfma_f32_16x16x32_bf16 v[96:99], v[56:59], v[212:215], v[96:99]
    ds_read_b64_tr_b16 v[46:47], v15 offset:21248
    buffer_load_dwordx4 v[192:195], v2, s[20:23], s58 offen offset:0 sc1
    v_mfma_f32_16x16x32_bf16 v[100:103], v[60:63], v[208:211], v[100:103]
    ds_read_b64_tr_b16 v[48:49], v21 offset:20512
    v_mfma_f32_16x16x32_bf16 v[104:107], v[60:63], v[212:215], v[104:107]
    ds_read_b64_tr_b16 v[50:51], v21 offset:21280
    v_mfma_f32_16x16x32_bf16 v[108:111], v[64:67], v[208:211], v[108:111]
    ds_read_b64_tr_b16 v[52:53], v15 offset:20544
    v_mfma_f32_16x16x32_bf16 v[112:115], v[64:67], v[212:215], v[112:115]
    ds_read_b64_tr_b16 v[54:55], v15 offset:21312
    s_waitcnt vmcnt(5)
    s_barrier
    s_waitcnt lgkmcnt(6)
    v_mfma_f32_16x16x32_bf16 v[68:71], v[32:35], v[216:219], v[68:71]
    ds_read_b64_tr_b16 v[56:57], v9 offset:49152
    v_mfma_f32_16x16x32_bf16 v[72:75], v[32:35], v[220:223], v[72:75]
    ds_read_b64_tr_b16 v[58:59], v9 offset:49920
    s_mov_b32 exec_lo, 0xffff
    s_mov_b32 exec_hi, 0xffff
    buffer_load_dwordx4 v[128:131], v3, s[20:23], s60 offen offset:0 sc1
    buffer_load_dwordx4 v[132:135], v3, s[20:23], s60 offen offset:512 sc1
    s_mov_b64 exec, -1
    v_mfma_f32_16x16x32_bf16 v[76:79], v[36:39], v[216:219], v[76:79]
    ds_read_b64_tr_b16 v[60:61], v10 offset:49184
    v_mfma_f32_16x16x32_bf16 v[80:83], v[36:39], v[220:223], v[80:83]
    ds_read_b64_tr_b16 v[62:63], v10 offset:49952
    v_mfma_f32_16x16x32_bf16 v[84:87], v[40:43], v[216:219], v[84:87]
    ds_read_b64_tr_b16 v[64:65], v9 offset:49216
    v_mfma_f32_16x16x32_bf16 v[88:91], v[40:43], v[220:223], v[88:91]
    ds_read_b64_tr_b16 v[66:67], v9 offset:49984
    s_waitcnt lgkmcnt(6)
    v_mfma_f32_16x16x32_bf16 v[92:95], v[44:47], v[216:219], v[92:95]
    ds_read_b64_tr_b16 v[32:33], v11 offset:49152
    v_mfma_f32_16x16x32_bf16 v[96:99], v[44:47], v[220:223], v[96:99]
    ds_read_b64_tr_b16 v[34:35], v11 offset:49920
    buffer_load_dwordx4 v[196:199], v2, s[20:23], s58 offen offset:1024 sc1
    v_mfma_f32_16x16x32_bf16 v[100:103], v[48:51], v[216:219], v[100:103]
    ds_read_b64_tr_b16 v[36:37], v12 offset:49184
    v_mfma_f32_16x16x32_bf16 v[104:107], v[48:51], v[220:223], v[104:107]
    ds_read_b64_tr_b16 v[38:39], v12 offset:49952
    v_mfma_f32_16x16x32_bf16 v[108:111], v[52:55], v[216:219], v[108:111]
    ds_read_b64_tr_b16 v[40:41], v11 offset:49216
    v_mfma_f32_16x16x32_bf16 v[112:115], v[52:55], v[220:223], v[112:115]
    ds_read_b64_tr_b16 v[42:43], v11 offset:49984
    s_waitcnt lgkmcnt(6)
    v_mfma_f32_16x16x32_bf16 v[68:71], v[56:59], v[224:227], v[68:71]
    ds_read_b64_tr_b16 v[44:45], v13 offset:49152
    v_mfma_f32_16x16x32_bf16 v[72:75], v[56:59], v[228:231], v[72:75]
    ds_read_b64_tr_b16 v[46:47], v13 offset:49920
    s_mov_b32 exec_lo, 0xffff
    s_mov_b32 exec_hi, 0xffff
    buffer_load_dwordx4 v[136:139], v3, s[20:23], s60 offen offset:1024 sc1
    buffer_load_dwordx4 v[140:143], v3, s[20:23], s60 offen offset:1536 sc1
    s_mov_b64 exec, -1
    v_mfma_f32_16x16x32_bf16 v[76:79], v[60:63], v[224:227], v[76:79]
    ds_read_b64_tr_b16 v[48:49], v14 offset:49184
    v_mfma_f32_16x16x32_bf16 v[80:83], v[60:63], v[228:231], v[80:83]
    ds_read_b64_tr_b16 v[50:51], v14 offset:49952
    v_mfma_f32_16x16x32_bf16 v[84:87], v[64:67], v[224:227], v[84:87]
    ds_read_b64_tr_b16 v[52:53], v13 offset:49216
    v_mfma_f32_16x16x32_bf16 v[88:91], v[64:67], v[228:231], v[88:91]
    ds_read_b64_tr_b16 v[54:55], v13 offset:49984
    v_smfmac_f32_16x16x64_bf16 v[120:123], v[124:127], v[56:63], v16
    v_mfma_f32_16x16x32_bf16 v[28:31], v[116:119], v[64:67], v[28:31]
    s_waitcnt lgkmcnt(6)
    v_mfma_f32_16x16x32_bf16 v[92:95], v[32:35], v[224:227], v[92:95]
    ds_read_b64_tr_b16 v[56:57], v15 offset:49152
    v_mfma_f32_16x16x32_bf16 v[96:99], v[32:35], v[228:231], v[96:99]
    ds_read_b64_tr_b16 v[58:59], v15 offset:49920
    buffer_load_dwordx4 v[200:203], v2, s[20:23], s58 offen offset:2048 sc1
    v_mfma_f32_16x16x32_bf16 v[100:103], v[36:39], v[224:227], v[100:103]
    ds_read_b64_tr_b16 v[60:61], v21 offset:49184
    v_mfma_f32_16x16x32_bf16 v[104:107], v[36:39], v[228:231], v[104:107]
    ds_read_b64_tr_b16 v[62:63], v21 offset:49952
    v_mfma_f32_16x16x32_bf16 v[108:111], v[40:43], v[224:227], v[108:111]
    ds_read_b64_tr_b16 v[64:65], v15 offset:49216
    v_mfma_f32_16x16x32_bf16 v[112:115], v[40:43], v[228:231], v[112:115]
    ds_read_b64_tr_b16 v[66:67], v15 offset:49984
    s_waitcnt vmcnt(8)
    s_barrier
    s_waitcnt lgkmcnt(6)
    v_add_u32 v9, 0xffff0000, v9
    v_add_u32 v10, 0xffff0000, v10
    v_mfma_f32_16x16x32_bf16 v[68:71], v[44:47], v[232:235], v[68:71]
    ds_read_b64_tr_b16 v[32:33], v9 offset:0
    v_mfma_f32_16x16x32_bf16 v[72:75], v[44:47], v[236:239], v[72:75]
    ds_read_b64_tr_b16 v[34:35], v9 offset:768
    buffer_load_dwordx4 v[224:227], v2, s[20:23], s64 offen sc1
    v_mfma_f32_16x16x32_bf16 v[76:79], v[48:51], v[232:235], v[76:79]
    ds_read_b64_tr_b16 v[36:37], v10 offset:32
    v_mfma_f32_16x16x32_bf16 v[80:83], v[48:51], v[236:239], v[80:83]
    ds_read_b64_tr_b16 v[38:39], v10 offset:800
    v_mfma_f32_16x16x32_bf16 v[84:87], v[52:55], v[232:235], v[84:87]
    ds_read_b64_tr_b16 v[40:41], v9 offset:64
    v_mfma_f32_16x16x32_bf16 v[88:91], v[52:55], v[236:239], v[88:91]
    ds_read_b64_tr_b16 v[42:43], v9 offset:832
    s_waitcnt lgkmcnt(6)
    v_add_u32 v11, 0xffff0000, v11
    v_add_u32 v12, 0xffff0000, v12
    v_mfma_f32_16x16x32_bf16 v[92:95], v[56:59], v[232:235], v[92:95]
    ds_read_b64_tr_b16 v[44:45], v11 offset:0
    v_mfma_f32_16x16x32_bf16 v[96:99], v[56:59], v[236:239], v[96:99]
    ds_read_b64_tr_b16 v[46:47], v11 offset:768
    s_mov_b32 exec_lo, 0xffff
    s_mov_b32 exec_hi, 0xffff
    buffer_load_dwordx4 v[144:147], v3, s[20:23], s60 offen offset:2048 sc1
    buffer_load_dwordx4 v[148:151], v3, s[20:23], s60 offen offset:2560 sc1
    s_mov_b64 exec, -1
    v_mfma_f32_16x16x32_bf16 v[100:103], v[60:63], v[232:235], v[100:103]
    ds_read_b64_tr_b16 v[48:49], v12 offset:32
    v_mfma_f32_16x16x32_bf16 v[104:107], v[60:63], v[236:239], v[104:107]
    ds_read_b64_tr_b16 v[50:51], v12 offset:800
    v_mfma_f32_16x16x32_bf16 v[108:111], v[64:67], v[232:235], v[108:111]
    ds_read_b64_tr_b16 v[52:53], v11 offset:64
    v_mfma_f32_16x16x32_bf16 v[112:115], v[64:67], v[236:239], v[112:115]
    ds_read_b64_tr_b16 v[54:55], v11 offset:832
    s_waitcnt lgkmcnt(6)
    v_add_u32 v13, 0xffff0000, v13
    v_add_u32 v14, 0xffff0000, v14
    v_mfma_f32_16x16x32_bf16 v[68:71], v[32:35], v[240:243], v[68:71]
    ds_read_b64_tr_b16 v[56:57], v13 offset:0
    v_mfma_f32_16x16x32_bf16 v[72:75], v[32:35], v[244:247], v[72:75]
    ds_read_b64_tr_b16 v[58:59], v13 offset:768
    buffer_load_dwordx4 v[204:207], v2, s[20:23], s58 offen offset:3072 sc1
    v_mfma_f32_16x16x32_bf16 v[76:79], v[36:39], v[240:243], v[76:79]
    ds_read_b64_tr_b16 v[60:61], v14 offset:32
    v_mfma_f32_16x16x32_bf16 v[80:83], v[36:39], v[244:247], v[80:83]
    ds_read_b64_tr_b16 v[62:63], v14 offset:800
    v_mfma_f32_16x16x32_bf16 v[84:87], v[40:43], v[240:243], v[84:87]
    ds_read_b64_tr_b16 v[64:65], v13 offset:64
    v_mfma_f32_16x16x32_bf16 v[88:91], v[40:43], v[244:247], v[88:91]
    ds_read_b64_tr_b16 v[66:67], v13 offset:832
    v_smfmac_f32_16x16x64_bf16 v[120:123], v[124:127], v[32:39], v16
    v_mfma_f32_16x16x32_bf16 v[28:31], v[116:119], v[40:43], v[28:31]
    s_and_b32 s50, s37, 1
    s_lshl_b32 s50, s50, 7
    s_lshr_b32 s48, s37, 1
    s_lshl_b32 s48, s48, 6
    s_add_u32 s48, s48, s50
    s_add_u32 s48, s48, 157696
    v_and_b32 v18, 15, v1
    v_lshl_add_u32 v18, v18, 2, s48
    s_nop 2
    v_add_f32 v120, v120, v121
    v_add_f32 v121, v122, v123
    ds_write_b32 v18, v120 offset:0
    ds_write_b32 v18, v121 offset:256
    s_waitcnt lgkmcnt(10)
    ds_write_b32 v18, v28 offset:512
    s_waitcnt lgkmcnt(9)
    v_add_u32 v15, 0xffff0000, v15
    v_add_u32 v21, 0xffff0000, v21
    v_mfma_f32_16x16x32_bf16 v[92:95], v[44:47], v[240:243], v[92:95]
    ds_read_b64_tr_b16 v[32:33], v15 offset:0
    v_mfma_f32_16x16x32_bf16 v[96:99], v[44:47], v[244:247], v[96:99]
    ds_read_b64_tr_b16 v[34:35], v15 offset:768
    s_mov_b32 exec_lo, 0xffff
    s_mov_b32 exec_hi, 0xffff
    buffer_load_dwordx4 v[152:155], v3, s[20:23], s60 offen offset:3072 sc1
    buffer_load_dwordx4 v[156:159], v3, s[20:23], s60 offen offset:3584 sc1
    s_mov_b64 exec, -1
    v_mfma_f32_16x16x32_bf16 v[100:103], v[48:51], v[240:243], v[100:103]
    ds_read_b64_tr_b16 v[36:37], v21 offset:32
    v_mfma_f32_16x16x32_bf16 v[104:107], v[48:51], v[244:247], v[104:107]
    ds_read_b64_tr_b16 v[38:39], v21 offset:800
    v_mfma_f32_16x16x32_bf16 v[108:111], v[52:55], v[240:243], v[108:111]
    ds_read_b64_tr_b16 v[40:41], v15 offset:64
    s_waitcnt lgkmcnt(10)
    v_mfma_f32_16x16x32_bf16 v[112:115], v[52:55], v[244:247], v[112:115]
    ds_read_b64_tr_b16 v[42:43], v15 offset:832
    s_waitcnt lgkmcnt(6)
    s_barrier
    v_mfma_f32_16x16x32_bf16 v[68:71], v[56:59], v[248:251], v[68:71]
    v_mfma_f32_16x16x32_bf16 v[72:75], v[56:59], v[252:255], v[72:75]
    s_add_u32 s48, s50, 157696
    v_lshrrev_b32 v6, 4, v1
    v_lshl_add_u32 v6, v6, 4, s48
    v_xor_b32 v7, 0x80, v6
    ds_read_b128 v[8:11], v6 offset:0
    ds_read_b128 v[44:47], v6 offset:64
    ds_read_b128 v[12:15], v6 offset:256
    ds_read_b128 v[48:51], v6 offset:320
    ds_read_b128 v[16:19], v6 offset:512
    ds_read_b128 v[52:55], v6 offset:576
    ds_read_b128 v[20:23], v7 offset:0
    ds_read_b128 v[116:119], v7 offset:64
    s_waitcnt lgkmcnt(10)
    ds_read_b128 v[232:235], v7 offset:256
    ds_read_b128 v[120:123], v7 offset:320
    ds_read_b128 v[236:239], v7 offset:512
    ds_read_b128 v[124:127], v7 offset:576
    s_waitcnt lgkmcnt(10)
    v_mfma_f32_16x16x32_bf16 v[76:79], v[60:63], v[248:251], v[76:79]
    v_mfma_f32_16x16x32_bf16 v[80:83], v[60:63], v[252:255], v[80:83]
    buffer_load_dwordx4 v[208:211], v2, s[20:23], s59 offen offset:0 sc1
    v_mfma_f32_16x16x32_bf16 v[84:87], v[64:67], v[248:251], v[84:87]
    v_mfma_f32_16x16x32_bf16 v[88:91], v[64:67], v[252:255], v[88:91]
    v_mfma_f32_16x16x32_bf16 v[92:95], v[32:35], v[248:251], v[92:95]
    v_mfma_f32_16x16x32_bf16 v[96:99], v[32:35], v[252:255], v[96:99]
    s_mov_b32 exec_lo, 0xffff
    s_mov_b32 exec_hi, 0xffff
    buffer_load_dwordx4 v[160:163], v3, s[20:23], s61 offen offset:0 sc1
    buffer_load_dwordx4 v[164:167], v3, s[20:23], s61 offen offset:512 sc1
    s_mov_b64 exec, -1
    v_mfma_f32_16x16x32_bf16 v[100:103], v[36:39], v[248:251], v[100:103]
    v_mfma_f32_16x16x32_bf16 v[104:107], v[36:39], v[252:255], v[104:107]
    v_mfma_f32_16x16x32_bf16 v[108:111], v[40:43], v[248:251], v[108:111]
    v_mfma_f32_16x16x32_bf16 v[112:115], v[40:43], v[252:255], v[112:115]
    s_setprio 3
    s_cmp_eq_u32 s50, 0
    s_cselect_b32 s48, 0xbfb8aa3b, 0
    s_cselect_b32 s49, 0, 0xbfb8aa3b
    v_mul_f32 v240, s48, v25
    v_mul_f32 v242, s48, v27
    v_mul_f32 v244, s49, v25
    v_mul_f32 v246, s49, v27
    v_mul_f32 v4, v25, v25
    v_mul_f32 v6, v27, v27
    v_rcp_f32 v4, v4
    v_rcp_f32 v6, v6
    s_lshl_b32 s52, s42, 2
    s_add_u32 s52, s52, s37
    s_mul_i32 s52, s52, 86
    s_lshr_b32 s53, s43, 1
    s_mul_i32 s53, s53, 11
    s_cmp_eq_u32 s55, 0
    s_cselect_b32 s48, 0, 10
    s_cselect_b32 s49, 1, -1
    s_add_u32 s53, s53, s48
    s_add_u32 s48, s52, s53
    s_lshl_b32 s48, s48, 10
    s_add_u32 s48, s48, 8388608
    s_cmp_lt_u32 s53, 86
    s_cselect_b32 s88, s48, 0x80000000
    s_add_u32 s53, s53, s49
    s_add_u32 s48, s52, s53
    s_lshl_b32 s48, s48, 10
    s_add_u32 s48, s48, 8388608
    s_cmp_lt_u32 s53, 86
    s_cselect_b32 s89, s48, 0x80000000
    s_add_u32 s53, s53, s49
    s_add_u32 s48, s52, s53
    s_lshl_b32 s48, s48, 10
    s_add_u32 s48, s48, 8388608
    s_cmp_lt_u32 s53, 86
    s_cselect_b32 s90, s48, 0x80000000
    s_add_u32 s53, s53, s49
    s_lshl_b32 s48, s55, 8
    v_xor_b32 v30, s48, v2
    s_waitcnt lgkmcnt(0)
    v_pk_add_f32 v[8:9], v[8:9], v[44:45]
    v_pk_add_f32 v[10:11], v[10:11], v[46:47]
    v_pk_add_f32 v[12:13], v[12:13], v[48:49]
    v_pk_add_f32 v[14:15], v[14:15], v[50:51]
    v_pk_add_f32 v[16:17], v[16:17], v[52:53]
    v_pk_add_f32 v[18:19], v[18:19], v[54:55]
    v_pk_add_f32 v[20:21], v[20:21], v[116:117]
    v_pk_add_f32 v[22:23], v[22:23], v[118:119]
    v_pk_add_f32 v[232:233], v[232:233], v[120:121]
    v_pk_add_f32 v[234:235], v[234:235], v[122:123]
    v_pk_add_f32 v[236:237], v[236:237], v[124:125]
    v_pk_add_f32 v[238:239], v[238:239], v[126:127]
    v_pk_fma_f32 v[68:69], v[8:9], v[24:25], v[68:69] op_sel_hi:[1,0,1]
    v_pk_fma_f32 v[92:93], v[20:21], v[24:25], v[92:93] op_sel_hi:[1,0,1]
    v_pk_fma_f32 v[70:71], v[10:11], v[24:25], v[70:71] op_sel_hi:[1,0,1]
    v_pk_fma_f32 v[94:95], v[22:23], v[24:25], v[94:95] op_sel_hi:[1,0,1]
    v_pk_fma_f32 v[72:73], v[8:9], v[26:27], v[72:73] op_sel_hi:[1,0,1]
    v_pk_fma_f32 v[96:97], v[20:21], v[26:27], v[96:97] op_sel_hi:[1,0,1]
    v_pk_fma_f32 v[74:75], v[10:11], v[26:27], v[74:75] op_sel_hi:[1,0,1]
    v_pk_fma_f32 v[98:99], v[22:23], v[26:27], v[98:99] op_sel_hi:[1,0,1]
    v_pk_mul_f32 v[32:33], v[68:69], v[240:241] op_sel_hi:[1,0]
    v_pk_mul_f32 v[34:35], v[70:71], v[240:241] op_sel_hi:[1,0]
    v_pk_mul_f32 v[36:37], v[72:73], v[242:243] op_sel_hi:[1,0]
    v_pk_mul_f32 v[38:39], v[74:75], v[242:243] op_sel_hi:[1,0]
    v_pk_fma_f32 v[32:33], v[92:93], v[244:245], v[32:33] op_sel_hi:[1,0,1]
    v_pk_fma_f32 v[34:35], v[94:95], v[244:245], v[34:35] op_sel_hi:[1,0,1]
    v_pk_fma_f32 v[36:37], v[96:97], v[246:247], v[36:37] op_sel_hi:[1,0,1]
    v_pk_fma_f32 v[38:39], v[98:99], v[246:247], v[38:39] op_sel_hi:[1,0,1]
    v_exp_f32 v32, v32
    v_exp_f32 v33, v33
    v_exp_f32 v34, v34
    v_exp_f32 v35, v35
    buffer_load_dwordx4 v[212:215], v2, s[20:23], s59 offen offset:1024 sc1
    v_exp_f32 v36, v36
    v_exp_f32 v37, v37
    v_exp_f32 v38, v38
    v_exp_f32 v39, v39
    s_mov_b32 exec_lo, 0xffff
    s_mov_b32 exec_hi, 0xffff
    buffer_load_dwordx4 v[168:171], v3, s[20:23], s61 offen offset:1024 sc1
    buffer_load_dwordx4 v[172:175], v3, s[20:23], s61 offen offset:1536 sc1
    s_mov_b64 exec, -1
    v_pk_mul_f32 v[68:69], v[68:69], v[92:93]
    v_pk_mul_f32 v[70:71], v[70:71], v[94:95]
    v_pk_mul_f32 v[72:73], v[72:73], v[96:97]
    v_pk_mul_f32 v[74:75], v[74:75], v[98:99]
    v_pk_fma_f32 v[32:33], v[32:33], v[4:5], v[4:5] op_sel_hi:[1,0,0]
    v_pk_fma_f32 v[34:35], v[34:35], v[4:5], v[4:5] op_sel_hi:[1,0,0]
    v_pk_fma_f32 v[36:37], v[36:37], v[6:7], v[6:7] op_sel_hi:[1,0,0]
    v_pk_fma_f32 v[38:39], v[38:39], v[6:7], v[6:7] op_sel_hi:[1,0,0]
    buffer_load_dwordx4 v[216:219], v2, s[20:23], s59 offen offset:2048 sc1
    v_rcp_f32 v32, v32
    v_rcp_f32 v33, v33
    v_rcp_f32 v34, v34
    v_rcp_f32 v35, v35
    s_mov_b32 exec_lo, 0xffff
    s_mov_b32 exec_hi, 0xffff
    buffer_load_dwordx4 v[176:179], v3, s[20:23], s61 offen offset:2048 sc1
    buffer_load_dwordx4 v[180:183], v3, s[20:23], s61 offen offset:2560 sc1
    s_mov_b64 exec, -1
    v_rcp_f32 v36, v36
    v_rcp_f32 v37, v37
    v_rcp_f32 v38, v38
    v_rcp_f32 v39, v39
    buffer_load_dwordx4 v[220:223], v2, s[20:23], s59 offen offset:3072 sc1
    s_nop 0
    v_pk_mul_f32 v[68:69], v[68:69], v[32:33]
    v_pk_mul_f32 v[70:71], v[70:71], v[34:35]
    v_pk_mul_f32 v[72:73], v[72:73], v[36:37]
    v_pk_mul_f32 v[74:75], v[74:75], v[38:39]
    v_cvt_pk_bf16_f32 v116, v68, v69
    v_cvt_pk_bf16_f32 v117, v70, v71
    v_cvt_pk_bf16_f32 v118, v72, v73
    v_cvt_pk_bf16_f32 v119, v74, v75
    s_nop 1
    v_permlane16_swap_b32 v116, v118
    v_permlane16_swap_b32 v117, v119
    v_pk_fma_f32 v[76:77], v[12:13], v[24:25], v[76:77] op_sel_hi:[1,0,1]
    v_pk_fma_f32 v[100:101], v[232:233], v[24:25], v[100:101] op_sel_hi:[1,0,1]
    v_pk_fma_f32 v[78:79], v[14:15], v[24:25], v[78:79] op_sel_hi:[1,0,1]
    v_pk_fma_f32 v[102:103], v[234:235], v[24:25], v[102:103] op_sel_hi:[1,0,1]
    v_pk_fma_f32 v[80:81], v[12:13], v[26:27], v[80:81] op_sel_hi:[1,0,1]
    v_pk_fma_f32 v[104:105], v[232:233], v[26:27], v[104:105] op_sel_hi:[1,0,1]
    v_pk_fma_f32 v[82:83], v[14:15], v[26:27], v[82:83] op_sel_hi:[1,0,1]
    v_pk_fma_f32 v[106:107], v[234:235], v[26:27], v[106:107] op_sel_hi:[1,0,1]
    v_pk_mul_f32 v[40:41], v[76:77], v[240:241] op_sel_hi:[1,0]
    v_pk_mul_f32 v[42:43], v[78:79], v[240:241] op_sel_hi:[1,0]
    v_pk_mul_f32 v[44:45], v[80:81], v[242:243] op_sel_hi:[1,0]
    v_pk_mul_f32 v[46:47], v[82:83], v[242:243] op_sel_hi:[1,0]
    v_pk_fma_f32 v[40:41], v[100:101], v[244:245], v[40:41] op_sel_hi:[1,0,1]
    v_pk_fma_f32 v[42:43], v[102:103], v[244:245], v[42:43] op_sel_hi:[1,0,1]
    v_pk_fma_f32 v[44:45], v[104:105], v[246:247], v[44:45] op_sel_hi:[1,0,1]
    v_pk_fma_f32 v[46:47], v[106:107], v[246:247], v[46:47] op_sel_hi:[1,0,1]
    v_exp_f32 v40, v40
    v_exp_f32 v41, v41
    v_exp_f32 v42, v42
    v_exp_f32 v43, v43
    s_mov_b32 exec_lo, 0xffff
    s_mov_b32 exec_hi, 0xffff
    buffer_load_dwordx4 v[184:187], v3, s[20:23], s61 offen offset:3072 sc1
    buffer_load_dwordx4 v[188:191], v3, s[20:23], s61 offen offset:3584 sc1
    s_mov_b64 exec, -1
    v_exp_f32 v44, v44
    v_exp_f32 v45, v45
    v_exp_f32 v46, v46
    v_exp_f32 v47, v47
    buffer_load_dwordx4 v[228:231], v2, s[20:23], s65 offen sc1
    v_pk_mul_f32 v[76:77], v[76:77], v[100:101]
    v_pk_mul_f32 v[78:79], v[78:79], v[102:103]
    v_pk_mul_f32 v[80:81], v[80:81], v[104:105]
    v_pk_mul_f32 v[82:83], v[82:83], v[106:107]
    v_pk_fma_f32 v[40:41], v[40:41], v[4:5], v[4:5] op_sel_hi:[1,0,0]
    v_pk_fma_f32 v[42:43], v[42:43], v[4:5], v[4:5] op_sel_hi:[1,0,0]
    v_pk_fma_f32 v[44:45], v[44:45], v[6:7], v[6:7] op_sel_hi:[1,0,0]
    v_pk_fma_f32 v[46:47], v[46:47], v[6:7], v[6:7] op_sel_hi:[1,0,0]
    v_rcp_f32 v40, v40
    v_rcp_f32 v41, v41
    v_rcp_f32 v42, v42
    v_rcp_f32 v43, v43
    v_rcp_f32 v44, v44
    v_rcp_f32 v45, v45
    v_rcp_f32 v46, v46
    v_rcp_f32 v47, v47
    s_nop 0
    v_pk_mul_f32 v[76:77], v[76:77], v[40:41]
    v_pk_mul_f32 v[78:79], v[78:79], v[42:43]
    v_pk_mul_f32 v[80:81], v[80:81], v[44:45]
    v_pk_mul_f32 v[82:83], v[82:83], v[46:47]
    v_cvt_pk_bf16_f32 v120, v76, v77
    v_cvt_pk_bf16_f32 v121, v78, v79
    v_cvt_pk_bf16_f32 v122, v80, v81
    v_cvt_pk_bf16_f32 v123, v82, v83
    s_nop 1
    v_permlane16_swap_b32 v120, v122
    v_permlane16_swap_b32 v121, v123
    v_pk_fma_f32 v[84:85], v[16:17], v[24:25], v[84:85] op_sel_hi:[1,0,1]
    v_pk_fma_f32 v[108:109], v[236:237], v[24:25], v[108:109] op_sel_hi:[1,0,1]
    v_pk_fma_f32 v[86:87], v[18:19], v[24:25], v[86:87] op_sel_hi:[1,0,1]
    v_pk_fma_f32 v[110:111], v[238:239], v[24:25], v[110:111] op_sel_hi:[1,0,1]
    v_pk_fma_f32 v[88:89], v[16:17], v[26:27], v[88:89] op_sel_hi:[1,0,1]
    v_pk_fma_f32 v[112:113], v[236:237], v[26:27], v[112:113] op_sel_hi:[1,0,1]
    v_pk_fma_f32 v[90:91], v[18:19], v[26:27], v[90:91] op_sel_hi:[1,0,1]
    v_pk_fma_f32 v[114:115], v[238:239], v[26:27], v[114:115] op_sel_hi:[1,0,1]
    v_pk_mul_f32 v[32:33], v[84:85], v[240:241] op_sel_hi:[1,0]
    v_pk_mul_f32 v[34:35], v[86:87], v[240:241] op_sel_hi:[1,0]
    v_pk_mul_f32 v[36:37], v[88:89], v[242:243] op_sel_hi:[1,0]
    v_pk_mul_f32 v[38:39], v[90:91], v[242:243] op_sel_hi:[1,0]
    v_pk_fma_f32 v[32:33], v[108:109], v[244:245], v[32:33] op_sel_hi:[1,0,1]
    v_pk_fma_f32 v[34:35], v[110:111], v[244:245], v[34:35] op_sel_hi:[1,0,1]
    v_pk_fma_f32 v[36:37], v[112:113], v[246:247], v[36:37] op_sel_hi:[1,0,1]
    v_pk_fma_f32 v[38:39], v[114:115], v[246:247], v[38:39] op_sel_hi:[1,0,1]
    v_exp_f32 v32, v32
    v_exp_f32 v33, v33
    v_exp_f32 v34, v34
    v_exp_f32 v35, v35
    v_exp_f32 v36, v36
    v_exp_f32 v37, v37
    v_exp_f32 v38, v38
    v_exp_f32 v39, v39
    v_pk_mul_f32 v[84:85], v[84:85], v[108:109]
    v_pk_mul_f32 v[86:87], v[86:87], v[110:111]
    v_pk_mul_f32 v[88:89], v[88:89], v[112:113]
    v_pk_mul_f32 v[90:91], v[90:91], v[114:115]
    v_pk_fma_f32 v[32:33], v[32:33], v[4:5], v[4:5] op_sel_hi:[1,0,0]
    v_pk_fma_f32 v[34:35], v[34:35], v[4:5], v[4:5] op_sel_hi:[1,0,0]
    v_pk_fma_f32 v[36:37], v[36:37], v[6:7], v[6:7] op_sel_hi:[1,0,0]
    v_pk_fma_f32 v[38:39], v[38:39], v[6:7], v[6:7] op_sel_hi:[1,0,0]
    v_rcp_f32 v32, v32
    v_rcp_f32 v33, v33
    v_rcp_f32 v34, v34
    v_rcp_f32 v35, v35
    v_rcp_f32 v36, v36
    v_rcp_f32 v37, v37
    v_rcp_f32 v38, v38
    v_rcp_f32 v39, v39
    s_nop 0
    v_pk_mul_f32 v[84:85], v[84:85], v[32:33]
    v_pk_mul_f32 v[86:87], v[86:87], v[34:35]
    v_pk_mul_f32 v[88:89], v[88:89], v[36:37]
    v_pk_mul_f32 v[90:91], v[90:91], v[38:39]
    v_cvt_pk_bf16_f32 v124, v84, v85
    v_cvt_pk_bf16_f32 v125, v86, v87
    v_cvt_pk_bf16_f32 v126, v88, v89
    v_cvt_pk_bf16_f32 v127, v90, v91
    s_nop 1
    v_permlane16_swap_b32 v124, v126
    v_permlane16_swap_b32 v125, v127
    s_branch L_am_3
L_a1_2:
    v_add_u32 v100, s84, v13
    v_add_u32 v102, s84, v14
    v_add_u32 v104, s85, v13
    v_add_u32 v106, s85, v14
    v_lshrrev_b32 v112, 5, v1
    v_bfe_u32 v108, v1, 1, 1
    v_cmp_eq_u32 vcc, v112, v108
    v_mov_b32 v111, s39
    v_and_b32 v112, 1, v1
    v_cndmask_b32 v108, 0, v111, vcc
    v_cndmask_b32 v109, 0, v111, vcc
    v_cndmask_b32 v110, 0, v111, vcc
    v_cndmask_b32 v111, 0, v111, vcc
    v_mul_u32_u24 v112, 0xaaaa, v112
    v_add_u32 v112, 0x4444, v112
    v_mov_b32 v84, 0
    v_mov_b32 v85, 0
    v_mov_b32 v86, 0
    v_mov_b32 v87, 0
    s_lshr_b32 s50, s37, 1
    s_and_b32 s51, s37, 1
    s_lshl_b32 s48, s50, 6
    s_lshl_b32 s49, s51, 7
    s_add_u32 s48, s48, s49
    s_add_u32 s48, s48, 158208
    v_and_b32 v22, 15, v1
    v_lshl_add_u32 v16, v22, 2, s48
    s_lshl_b32 s52, s37, 8
    s_add_u32 s52, s52, 143360
    v_lshl_add_u32 v23, v22, 2, s52
    v_lshrrev_b32 v18, 4, v1
    s_add_u32 s48, s49, 158208
    s_lshl_b32 s49, s42, 2
    s_add_u32 s49, s49, s37
    s_lshl_b32 s49, s49, 10
    v_lshl_add_u32 v19, v22, 2, s48
    v_xor_b32 v20, 0x80, v19
    v_lshl_add_u32 v18, v18, 4, s52
    s_lshl_b32 s48, s43, 17
    s_add_u32 s49, s49, s48
    s_add_u32 s49, s49, 4194304
    s_lshl_b32 s48, s51, 16
    s_add_u32 s0, s49, s48
    s_xor_b32 s48, s48, 0x10000
    s_add_u32 s1, s49, s48
    v_lshrrev_b32 v17, 5, v1
    v_lshlrev_b32 v17, 8, v17
    v_lshl_add_u32 v17, v22, 4, v17
    v_bfe_u32 v26, v1, 4, 1
    v_xor_b32 v26, s55, v26
    v_lshl_add_u32 v17, v26, 9, v17
    v_and_b32 v26, 1, v1
    v_and_b32 v27, 2, v1
    v_cmp_ne_u32 s[80:81], 0, v26
    v_cmp_ne_u32 s[82:83], 0, v27
    s_waitcnt lgkmcnt(0)
    s_mul_i32 s3, s3, 0x9e3779b1
    s_add_u32 s3, s3, 0x7f4a7c15
    s_waitcnt vmcnt(4)
    s_barrier
    ds_read_b128 v[128:131], v9 offset:0
    ds_read_b128 v[132:135], v10 offset:0
    ds_read_b64_tr_b16 v[32:33], v100 offset:0
    ds_read_b64_tr_b16 v[34:35], v100 offset:256
    ds_read_b64_tr_b16 v[44:45], v102 offset:0
    ds_read_b64_tr_b16 v[46:47], v102 offset:256
    s_waitcnt lgkmcnt(2)
    v_mfma_f32_16x16x32_bf16 v[68:71], v[128:131], v[32:35], 0
    ds_read_b64_tr_b16 v[56:57], v104 offset:0
    v_mfma_f32_16x16x32_bf16 v[72:75], v[132:135], v[32:35], 0
    ds_read_b64_tr_b16 v[58:59], v104 offset:256
    ds_read_b128 v[136:139], v11 offset:0
    ds_read_b128 v[140:143], v12 offset:0
    s_add_u32 s53, s54, 2
    s_and_b32 s53, s53, 7
    s_add_u32 m0, s92, 57344
    s_mul_i32 s7, s53, 128
    buffer_load_dwordx4 v2, s[8:11], s7 offen offset:0 lds
    v_mfma_f32_16x16x32_bf16 v[120:123], v[116:119], v[32:35], 0
    v_smfmac_f32_16x16x64_bf16 v[84:87], v[108:111], v[128:135], v112
    v_mfma_f32_16x16x32_bf16 v[92:95], v[128:131], v[128:131], 0
    buffer_load_dwordx4 v3, s[8:11], s7 offen offset:1024 lds
    s_waitcnt lgkmcnt(4)
    v_mfma_f32_16x16x32_bf16 v[76:79], v[128:131], v[44:47], 0
    ds_read_b64_tr_b16 v[32:33], v106 offset:0
    v_mfma_f32_16x16x32_bf16 v[80:83], v[132:135], v[44:47], 0
    ds_read_b64_tr_b16 v[34:35], v106 offset:256
    s_add_u32 m0, s93, 73728
    s_mul_i32 s7, s53, 196608
    buffer_load_dwordx4 v4, s[12:15], s7 offen offset:0 lds
    v_mfma_f32_16x16x32_bf16 v[96:99], v[132:135], v[132:135], 0
    s_add_u32 m0, s94, 81920
    s_mov_b32 exec_hi, 0
    buffer_load_dwordx4 v5, s[12:15], s7 offen offset:0 lds
    s_mov_b32 exec_hi, -1
    s_waitcnt vmcnt(4)
    s_barrier
    s_waitcnt lgkmcnt(2)
    v_mfma_f32_16x16x32_bf16 v[68:71], v[136:139], v[56:59], v[68:71]
    ds_read_b64_tr_b16 v[44:45], v100 offset:28672
    v_mfma_f32_16x16x32_bf16 v[72:75], v[140:143], v[56:59], v[72:75]
    ds_read_b64_tr_b16 v[46:47], v100 offset:28928
    ds_read_b128 v[144:147], v9 offset:28672
    ds_read_b128 v[148:151], v10 offset:28672
    s_add_u32 s53, s54, 3
    s_and_b32 s53, s53, 7
    s_add_u32 m0, s92, 86016
    s_mul_i32 s7, s53, 128
    buffer_load_dwordx4 v2, s[8:11], s7 offen offset:0 lds
    v_smfmac_f32_16x16x64_bf16 v[84:87], v[108:111], v[136:143], v112
    v_mfma_f32_16x16x32_bf16 v[92:95], v[136:139], v[136:139], v[92:95]
    buffer_load_dwordx4 v3, s[8:11], s7 offen offset:1024 lds
    s_waitcnt lgkmcnt(4)
    v_mfma_f32_16x16x32_bf16 v[76:79], v[136:139], v[32:35], v[76:79]
    ds_read_b64_tr_b16 v[56:57], v102 offset:28672
    v_mfma_f32_16x16x32_bf16 v[80:83], v[140:143], v[32:35], v[80:83]
    ds_read_b64_tr_b16 v[58:59], v102 offset:28928
    s_add_u32 m0, s93, 102400
    s_mul_i32 s7, s53, 196608
    buffer_load_dwordx4 v4, s[12:15], s7 offen offset:0 lds
    v_mfma_f32_16x16x32_bf16 v[96:99], v[140:143], v[140:143], v[96:99]
    s_add_u32 m0, s94, 110592
    s_mov_b32 exec_hi, 0
    buffer_load_dwordx4 v5, s[12:15], s7 offen offset:0 lds
    s_mov_b32 exec_hi, -1
    s_waitcnt lgkmcnt(2)
    v_mfma_f32_16x16x32_bf16 v[68:71], v[144:147], v[44:47], v[68:71]
    ds_read_b64_tr_b16 v[32:33], v104 offset:28672
    v_mfma_f32_16x16x32_bf16 v[72:75], v[148:151], v[44:47], v[72:75]
    ds_read_b64_tr_b16 v[34:35], v104 offset:28928
    ds_read_b128 v[152:155], v11 offset:28672
    ds_read_b128 v[156:159], v12 offset:28672
    s_add_u32 s53, s54, 4
    s_and_b32 s53, s53, 7
    s_add_u32 m0, s92, 114688
    s_mul_i32 s7, s53, 128
    buffer_load_dwordx4 v2, s[8:11], s7 offen offset:0 lds
    v_mfma_f32_16x16x32_bf16 v[120:123], v[116:119], v[44:47], v[120:123]
    v_smfmac_f32_16x16x64_bf16 v[84:87], v[108:111], v[144:151], v112
    v_mfma_f32_16x16x32_bf16 v[92:95], v[144:147], v[144:147], v[92:95]
    s_waitcnt lgkmcnt(4)
    v_mfma_f32_16x16x32_bf16 v[76:79], v[144:147], v[56:59], v[76:79]
    ds_read_b64_tr_b16 v[44:45], v106 offset:28672
    v_mfma_f32_16x16x32_bf16 v[80:83], v[148:151], v[56:59], v[80:83]
    ds_read_b64_tr_b16 v[46:47], v106 offset:28928
    buffer_load_dwordx4 v3, s[8:11], s7 offen offset:1024 lds
    v_mfma_f32_16x16x32_bf16 v[96:99], v[148:151], v[148:151], v[96:99]
    s_waitcnt vmcnt(6)
    s_barrier
    s_waitcnt lgkmcnt(2)
    v_mfma_f32_16x16x32_bf16 v[68:71], v[152:155], v[32:35], v[68:71]
    ds_read_b64_tr_b16 v[56:57], v100 offset:57344
    v_mfma_f32_16x16x32_bf16 v[72:75], v[156:159], v[32:35], v[72:75]
    ds_read_b64_tr_b16 v[58:59], v100 offset:57600
    ds_read_b128 v[160:163], v9 offset:57344
    ds_read_b128 v[164:167], v10 offset:57344
    s_add_u32 m0, s93, 131072
    s_mul_i32 s7, s53, 196608
    buffer_load_dwordx4 v4, s[12:15], s7 offen offset:0 lds
    v_smfmac_f32_16x16x64_bf16 v[84:87], v[108:111], v[152:159], v112
    v_mfma_f32_16x16x32_bf16 v[92:95], v[152:155], v[152:155], v[92:95]
    s_add_u32 m0, s94, 139264
    s_mov_b32 exec_hi, 0
    buffer_load_dwordx4 v5, s[12:15], s7 offen offset:0 lds
    s_mov_b32 exec_hi, -1
    s_waitcnt lgkmcnt(4)
    v_mfma_f32_16x16x32_bf16 v[76:79], v[152:155], v[44:47], v[76:79]
    ds_read_b64_tr_b16 v[32:33], v102 offset:57344
    v_mfma_f32_16x16x32_bf16 v[80:83], v[156:159], v[44:47], v[80:83]
    ds_read_b64_tr_b16 v[34:35], v102 offset:57600
    s_add_u32 s53, s54, 5
    s_and_b32 s53, s53, 7
    s_add_u32 m0, s92, 0
    s_mul_i32 s7, s53, 128
    buffer_load_dwordx4 v2, s[8:11], s7 offen offset:0 lds
    v_mfma_f32_16x16x32_bf16 v[96:99], v[156:159], v[156:159], v[96:99]
    s_waitcnt lgkmcnt(2)
    v_mfma_f32_16x16x32_bf16 v[68:71], v[160:163], v[56:59], v[68:71]
    ds_read_b64_tr_b16 v[44:45], v104 offset:57344
    v_mfma_f32_16x16x32_bf16 v[72:75], v[164:167], v[56:59], v[72:75]
    ds_read_b64_tr_b16 v[46:47], v104 offset:57600
    ds_read_b128 v[168:171], v11 offset:57344
    ds_read_b128 v[172:175], v12 offset:57344
    buffer_load_dwordx4 v3, s[8:11], s7 offen offset:1024 lds
    v_mfma_f32_16x16x32_bf16 v[120:123], v[116:119], v[56:59], v[120:123]
    v_smfmac_f32_16x16x64_bf16 v[84:87], v[108:111], v[160:167], v112
    v_mfma_f32_16x16x32_bf16 v[92:95], v[160:163], v[160:163], v[92:95]
    s_waitcnt lgkmcnt(4)
    v_mfma_f32_16x16x32_bf16 v[76:79], v[160:163], v[32:35], v[76:79]
    ds_read_b64_tr_b16 v[56:57], v106 offset:57344
    v_mfma_f32_16x16x32_bf16 v[80:83], v[164:167], v[32:35], v[80:83]
    ds_read_b64_tr_b16 v[58:59], v106 offset:57600
    s_add_u32 m0, s93, 16384
    s_mul_i32 s7, s53, 196608
    buffer_load_dwordx4 v4, s[12:15], s7 offen offset:0 lds
    v_mfma_f32_16x16x32_bf16 v[96:99], v[164:167], v[164:167], v[96:99]
    s_waitcnt vmcnt(7)
    s_barrier
    s_waitcnt lgkmcnt(2)
    v_add_u32 v100, 0x10000, v100
    v_mfma_f32_16x16x32_bf16 v[68:71], v[168:171], v[44:47], v[68:71]
    ds_read_b64_tr_b16 v[32:33], v100 offset:20480
    v_mfma_f32_16x16x32_bf16 v[72:75], v[172:175], v[44:47], v[72:75]
    ds_read_b64_tr_b16 v[34:35], v100 offset:20736
    v_add_u32 v9, 0x10000, v9
    ds_read_b128 v[176:179], v9 offset:20480
    v_add_u32 v10, 0x10000, v10
    ds_read_b128 v[180:183], v10 offset:20480
    s_add_u32 m0, s94, 24576
    s_mov_b32 exec_hi, 0
    buffer_load_dwordx4 v5, s[12:15], s7 offen offset:0 lds
    s_mov_b32 exec_hi, -1
    v_smfmac_f32_16x16x64_bf16 v[84:87], v[108:111], v[168:175], v112
    v_mfma_f32_16x16x32_bf16 v[92:95], v[168:171], v[168:171], v[92:95]
    s_add_u32 s53, s54, 6
    s_and_b32 s53, s53, 7
    s_add_u32 m0, s92, 28672
    s_mul_i32 s7, s53, 128
    buffer_load_dwordx4 v2, s[8:11], s7 offen offset:0 lds
    s_waitcnt lgkmcnt(4)
    v_add_u32 v102, 0x10000, v102
    v_mfma_f32_16x16x32_bf16 v[76:79], v[168:171], v[56:59], v[76:79]
    ds_read_b64_tr_b16 v[44:45], v102 offset:20480
    v_mfma_f32_16x16x32_bf16 v[80:83], v[172:175], v[56:59], v[80:83]
    ds_read_b64_tr_b16 v[46:47], v102 offset:20736
    buffer_load_dwordx4 v3, s[8:11], s7 offen offset:1024 lds
    v_mfma_f32_16x16x32_bf16 v[96:99], v[172:175], v[172:175], v[96:99]
    s_waitcnt lgkmcnt(2)
    v_add_u32 v104, 0x10000, v104
    v_mfma_f32_16x16x32_bf16 v[68:71], v[176:179], v[32:35], v[68:71]
    ds_read_b64_tr_b16 v[56:57], v104 offset:20480
    v_mfma_f32_16x16x32_bf16 v[72:75], v[180:183], v[32:35], v[72:75]
    ds_read_b64_tr_b16 v[58:59], v104 offset:20736
    v_add_u32 v11, 0x10000, v11
    ds_read_b128 v[184:187], v11 offset:20480
    v_add_u32 v12, 0x10000, v12
    ds_read_b128 v[188:191], v12 offset:20480
    s_add_u32 m0, s93, 45056
    s_mul_i32 s7, s53, 196608
    buffer_load_dwordx4 v4, s[12:15], s7 offen offset:0 lds
    v_mfma_f32_16x16x32_bf16 v[120:123], v[116:119], v[32:35], v[120:123]
    v_smfmac_f32_16x16x64_bf16 v[84:87], v[108:111], v[176:183], v112
    v_mfma_f32_16x16x32_bf16 v[92:95], v[176:179], v[176:179], v[92:95]
    s_waitcnt lgkmcnt(4)
    v_add_u32 v106, 0x10000, v106
    v_mfma_f32_16x16x32_bf16 v[76:79], v[176:179], v[44:47], v[76:79]
    ds_read_b64_tr_b16 v[32:33], v106 offset:20480
    v_mfma_f32_16x16x32_bf16 v[80:83], v[180:183], v[44:47], v[80:83]
    ds_read_b64_tr_b16 v[34:35], v106 offset:20736
    s_add_u32 m0, s94, 53248
    s_mov_b32 exec_hi, 0
    buffer_load_dwordx4 v5, s[12:15], s7 offen offset:0 lds
    s_mov_b32 exec_hi, -1
    v_mfma_f32_16x16x32_bf16 v[96:99], v[180:183], v[180:183], v[96:99]
    s_waitcnt vmcnt(8)
    s_barrier
    s_waitcnt lgkmcnt(2)
    v_mfma_f32_16x16x32_bf16 v[68:71], v[184:187], v[56:59], v[68:71]
    ds_read_b64_tr_b16 v[44:45], v100 offset:49152
    v_mfma_f32_16x16x32_bf16 v[72:75], v[188:191], v[56:59], v[72:75]
    ds_read_b64_tr_b16 v[46:47], v100 offset:49408
    ds_read_b128 v[192:195], v9 offset:49152
    ds_read_b128 v[196:199], v10 offset:49152
    s_add_u32 s53, s54, 7
    s_and_b32 s53, s53, 7
    s_add_u32 m0, s92, 57344
    s_mul_i32 s7, s53, 128
    buffer_load_dwordx4 v2, s[8:11], s7 offen offset:0 lds
    v_smfmac_f32_16x16x64_bf16 v[84:87], v[108:111], v[184:191], v112
    v_mfma_f32_16x16x32_bf16 v[92:95], v[184:187], v[184:187], v[92:95]
    s_waitcnt lgkmcnt(4)
    v_mfma_f32_16x16x32_bf16 v[76:79], v[184:187], v[32:35], v[76:79]
    ds_read_b64_tr_b16 v[56:57], v102 offset:49152
    v_mfma_f32_16x16x32_bf16 v[80:83], v[188:191], v[32:35], v[80:83]
    ds_read_b64_tr_b16 v[58:59], v102 offset:49408
    buffer_load_dwordx4 v3, s[8:11], s7 offen offset:1024 lds
    v_mfma_f32_16x16x32_bf16 v[96:99], v[188:191], v[188:191], v[96:99]
    s_waitcnt lgkmcnt(2)
    v_mfma_f32_16x16x32_bf16 v[68:71], v[192:195], v[44:47], v[68:71]
    ds_read_b64_tr_b16 v[32:33], v104 offset:49152
    v_mfma_f32_16x16x32_bf16 v[72:75], v[196:199], v[44:47], v[72:75]
    ds_read_b64_tr_b16 v[34:35], v104 offset:49408
    ds_read_b128 v[200:203], v11 offset:49152
    ds_read_b128 v[204:207], v12 offset:49152
    s_add_u32 m0, s93, 73728
    s_mul_i32 s7, s53, 196608
    buffer_load_dwordx4 v4, s[12:15], s7 offen offset:0 lds
    v_mfma_f32_16x16x32_bf16 v[120:123], v[116:119], v[44:47], v[120:123]
    v_smfmac_f32_16x16x64_bf16 v[84:87], v[108:111], v[192:199], v112
    v_mfma_f32_16x16x32_bf16 v[92:95], v[192:195], v[192:195], v[92:95]
    s_waitcnt lgkmcnt(4)
    v_mfma_f32_16x16x32_bf16 v[76:79], v[192:195], v[56:59], v[76:79]
    ds_read_b64_tr_b16 v[44:45], v106 offset:49152
    v_mfma_f32_16x16x32_bf16 v[80:83], v[196:199], v[56:59], v[80:83]
    ds_read_b64_tr_b16 v[46:47], v106 offset:49408
    s_add_u32 m0, s94, 81920
    s_mov_b32 exec_hi, 0
    buffer_load_dwordx4 v5, s[12:15], s7 offen offset:0 lds
    s_mov_b32 exec_hi, -1
    v_mfma_f32_16x16x32_bf16 v[96:99], v[196:199], v[196:199], v[96:99]
    s_waitcnt vmcnt(8)
    s_barrier
    s_waitcnt lgkmcnt(2)
    v_add_u32 v100, 0xffff0000, v100
    v_mfma_f32_16x16x32_bf16 v[68:71], v[200:203], v[32:35], v[68:71]
    ds_read_b64_tr_b16 v[56:57], v100 offset:0
    v_mfma_f32_16x16x32_bf16 v[72:75], v[204:207], v[32:35], v[72:75]
    ds_read_b64_tr_b16 v[58:59], v100 offset:256
    v_add_u32 v9, 0xffff0000, v9
    ds_read_b128 v[208:211], v9 offset:0
    v_add_u32 v10, 0xffff0000, v10
    ds_read_b128 v[212:215], v10 offset:0
    s_add_u32 s53, s54, 0
    s_and_b32 s53, s53, 7
    s_add_u32 m0, s95, 86016
    s_mul_i32 s7, s53, 176128
    buffer_load_dwordx4 v6, s[16:19], s7 offen offset:0 lds
    v_smfmac_f32_16x16x64_bf16 v[84:87], v[108:111], v[200:207], v112
    v_mfma_f32_16x16x32_bf16 v[92:95], v[200:203], v[200:203], v[92:95]
    s_waitcnt lgkmcnt(4)
    v_add_u32 v102, 0xffff0000, v102
    v_mfma_f32_16x16x32_bf16 v[76:79], v[200:203], v[44:47], v[76:79]
    ds_read_b64_tr_b16 v[32:33], v102 offset:0
    v_mfma_f32_16x16x32_bf16 v[80:83], v[204:207], v[44:47], v[80:83]
    ds_read_b64_tr_b16 v[34:35], v102 offset:256
    buffer_load_dwordx4 v7, s[16:19], s7 offen offset:1024 lds
    v_mfma_f32_16x16x32_bf16 v[96:99], v[204:207], v[204:207], v[96:99]
    s_waitcnt lgkmcnt(2)
    v_add_u32 v104, 0xffff0000, v104
    v_mfma_f32_16x16x32_bf16 v[68:71], v[208:211], v[56:59], v[68:71]
    ds_read_b64_tr_b16 v[44:45], v104 offset:0
    v_mfma_f32_16x16x32_bf16 v[72:75], v[212:215], v[56:59], v[72:75]
    ds_read_b64_tr_b16 v[46:47], v104 offset:256
    v_add_u32 v11, 0xffff0000, v11
    ds_read_b128 v[216:219], v11 offset:0
    v_add_u32 v12, 0xffff0000, v12
    ds_read_b128 v[220:223], v12 offset:0
    buffer_load_dwordx4 v8, s[16:19], s7 offen offset:2048 lds
    v_mfma_f32_16x16x32_bf16 v[120:123], v[116:119], v[56:59], v[120:123]
    v_smfmac_f32_16x16x64_bf16 v[84:87], v[108:111], v[208:215], v112
    v_mfma_f32_16x16x32_bf16 v[92:95], v[208:211], v[208:211], v[92:95]
    s_waitcnt lgkmcnt(4)
    v_add_u32 v106, 0xffff0000, v106
    v_mfma_f32_16x16x32_bf16 v[76:79], v[208:211], v[32:35], v[76:79]
    ds_read_b64_tr_b16 v[56:57], v106 offset:0
    v_mfma_f32_16x16x32_bf16 v[80:83], v[212:215], v[32:35], v[80:83]
    ds_read_b64_tr_b16 v[58:59], v106 offset:256
    v_mfma_f32_16x16x32_bf16 v[96:99], v[212:215], v[212:215], v[96:99]
    s_waitcnt vmcnt(7)
    s_barrier
    s_waitcnt lgkmcnt(2)
    v_mfma_f32_16x16x32_bf16 v[68:71], v[216:219], v[44:47], v[68:71]
    ds_read_b64_tr_b16 v[32:33], v100 offset:28672
    v_mfma_f32_16x16x32_bf16 v[72:75], v[220:223], v[44:47], v[72:75]
    ds_read_b64_tr_b16 v[34:35], v100 offset:28928
    ds_read_b128 v[224:227], v9 offset:28672
    ds_read_b128 v[228:231], v10 offset:28672
    v_smfmac_f32_16x16x64_bf16 v[84:87], v[108:111], v[216:223], v112
    v_mfma_f32_16x16x32_bf16 v[92:95], v[216:219], v[216:219], v[92:95]
    s_waitcnt lgkmcnt(4)
    v_mfma_f32_16x16x32_bf16 v[76:79], v[216:219], v[56:59], v[76:79]
    ds_read_b64_tr_b16 v[44:45], v102 offset:28672
    v_mfma_f32_16x16x32_bf16 v[80:83], v[220:223], v[56:59], v[80:83]
    ds_read_b64_tr_b16 v[46:47], v102 offset:28928
    v_mfma_f32_16x16x32_bf16 v[96:99], v[220:223], v[220:223], v[96:99]
    s_waitcnt lgkmcnt(2)
    v_mfma_f32_16x16x32_bf16 v[68:71], v[224:227], v[32:35], v[68:71]
    ds_read_b64_tr_b16 v[56:57], v104 offset:28672
    v_mfma_f32_16x16x32_bf16 v[72:75], v[228:231], v[32:35], v[72:75]
    ds_read_b64_tr_b16 v[58:59], v104 offset:28928
    ds_read_b128 v[232:235], v11 offset:28672
    ds_read_b128 v[236:239], v12 offset:28672
    v_mfma_f32_16x16x32_bf16 v[120:123], v[116:119], v[32:35], v[120:123]
    v_smfmac_f32_16x16x64_bf16 v[84:87], v[108:111], v[224:231], v112
    v_mfma_f32_16x16x32_bf16 v[92:95], v[224:227], v[224:227], v[92:95]
    s_waitcnt lgkmcnt(4)
    v_mfma_f32_16x16x32_bf16 v[76:79], v[224:227], v[44:47], v[76:79]
    ds_read_b64_tr_b16 v[32:33], v106 offset:28672
    v_mfma_f32_16x16x32_bf16 v[80:83], v[228:231], v[44:47], v[80:83]
    ds_read_b64_tr_b16 v[34:35], v106 offset:28928
    v_mfma_f32_16x16x32_bf16 v[96:99], v[228:231], v[228:231], v[96:99]
    s_waitcnt vmcnt(3)
    s_barrier
    s_waitcnt lgkmcnt(2)
    v_mfma_f32_16x16x32_bf16 v[68:71], v[232:235], v[56:59], v[68:71]
    ds_read_b64_tr_b16 v[44:45], v100 offset:57344
    v_mfma_f32_16x16x32_bf16 v[72:75], v[236:239], v[56:59], v[72:75]
    ds_read_b64_tr_b16 v[46:47], v100 offset:57600
    ds_read_b128 v[240:243], v9 offset:57344
    ds_read_b128 v[244:247], v10 offset:57344
    ds_read_b128 v[248:251], v11 offset:57344
    ds_read_b128 v[252:255], v12 offset:57344
    s_add_u32 s53, s54, 1
    s_and_b32 s53, s53, 7
    s_add_u32 m0, s95, 114688
    s_mul_i32 s7, s53, 176128
    buffer_load_dwordx4 v6, s[16:19], s7 offen offset:0 lds
    v_smfmac_f32_16x16x64_bf16 v[84:87], v[108:111], v[232:239], v112
    v_mfma_f32_16x16x32_bf16 v[92:95], v[232:235], v[232:235], v[92:95]
    s_waitcnt lgkmcnt(6)
    v_mfma_f32_16x16x32_bf16 v[76:79], v[232:235], v[32:35], v[76:79]
    ds_read_b64_tr_b16 v[56:57], v102 offset:57344
    v_mfma_f32_16x16x32_bf16 v[80:83], v[236:239], v[32:35], v[80:83]
    ds_read_b64_tr_b16 v[58:59], v102 offset:57600
    buffer_load_dwordx4 v7, s[16:19], s7 offen offset:1024 lds
    v_mfma_f32_16x16x32_bf16 v[96:99], v[236:239], v[236:239], v[96:99]
    s_waitcnt lgkmcnt(4)
    v_smfmac_f32_16x16x64_bf16 v[84:87], v[108:111], v[240:247], v112
    v_mfma_f32_16x16x32_bf16 v[92:95], v[240:243], v[240:243], v[92:95]
    s_waitcnt lgkmcnt(2)
    v_smfmac_f32_16x16x64_bf16 v[84:87], v[108:111], v[248:255], v112
    v_mfma_f32_16x16x32_bf16 v[92:95], v[248:251], v[248:251], v[92:95]
    v_mfma_f32_16x16x32_bf16 v[68:71], v[240:243], v[44:47], v[68:71]
    ds_read_b64_tr_b16 v[32:33], v104 offset:57344
    v_mfma_f32_16x16x32_bf16 v[72:75], v[244:247], v[44:47], v[72:75]
    ds_read_b64_tr_b16 v[34:35], v104 offset:57600
    buffer_load_dwordx4 v8, s[16:19], s7 offen offset:2048 lds
    v_mfma_f32_16x16x32_bf16 v[120:123], v[116:119], v[44:47], v[120:123]
    v_mfma_f32_16x16x32_bf16 v[96:99], v[244:247], v[244:247], v[96:99]
    v_mfma_f32_16x16x32_bf16 v[96:99], v[252:255], v[252:255], v[96:99]
    s_waitcnt lgkmcnt(2)
    v_mfma_f32_16x16x32_bf16 v[76:79], v[240:243], v[56:59], v[76:79]
    ds_read_b64_tr_b16 v[44:45], v106 offset:57344
    v_mfma_f32_16x16x32_bf16 v[80:83], v[244:247], v[56:59], v[80:83]
    ds_read_b64_tr_b16 v[46:47], v106 offset:57600
    s_add_u32 s53, s54, 2
    s_and_b32 s53, s53, 7
    s_add_u32 m0, s95, 0
    s_mul_i32 s7, s53, 176128
    buffer_load_dwordx4 v6, s[16:19], s7 offen offset:0 lds
    v_add_f32 v84, v84, v85
    v_cndmask_b32 v92, v92, v93, s[80:81]
    v_cndmask_b32 v94, v94, v95, s[80:81]
    v_mul_f32 v84, 0xbb000000, v84
    v_cndmask_b32 v92, v92, v94, s[82:83]
    v_mul_f32 v92, 0x3b000000, v92
    v_fma_f32 v92, -v84, v84, v92
    v_max_f32 v92, 0, v92
    v_add_f32 v92, 0x3727c5ac, v92
    v_rsq_f32 v92, v92
    v_add_f32 v88, v86, v87
    v_cndmask_b32 v96, v96, v97, s[80:81]
    v_cndmask_b32 v98, v98, v99, s[80:81]
    v_mul_f32 v88, 0xbb000000, v88
    v_cndmask_b32 v96, v96, v98, s[82:83]
    v_mul_f32 v96, 0x3b000000, v96
    v_fma_f32 v96, -v88, v88, v96
    v_max_f32 v96, 0, v96
    v_add_f32 v96, 0x3727c5ac, v96
    v_rsq_f32 v96, v96
    ds_write_b32 v16, v120 offset:0
    s_mov_b32 exec_lo, 0x00f0000f
    s_mov_b32 exec_hi, 0xf0000f00
    ds_write_b32 v23, v84 offset:0
    ds_write_b32 v23, v92 offset:64
    ds_write_b32 v23, v88 offset:128
    ds_write_b32 v23, v96 offset:192
    s_mov_b64 exec, -1
    s_waitcnt lgkmcnt(0)
    s_waitcnt vmcnt(4)
    s_barrier
    s_add_u32 s48, s88, 0x10000
    v_add_u32 v9, s48, v15
    v_add_u32 v10, s48, v21
    s_add_u32 s48, s89, 0x10000
    v_add_u32 v11, s48, v15
    v_add_u32 v12, s48, v21
    s_add_u32 s48, s90, 0x10000
    v_add_u32 v13, s48, v15
    v_add_u32 v14, s48, v21
    s_add_u32 s48, s91, 0x10000
    v_add_u32 v15, s48, v15
    v_add_u32 v21, s48, v21
    v_mfma_f32_16x16x32_bf16 v[68:71], v[248:251], v[32:35], v[68:71]
    ds_read_b64_tr_b16 v[56:57], v10 offset:20576
    v_mfma_f32_16x16x32_bf16 v[72:75], v[252:255], v[32:35], v[72:75]
    ds_read_b64_tr_b16 v[58:59], v10 offset:21344
    ds_read_b32 v24, v23 offset:0
    ds_read_b32 v25, v23 offset:64
    ds_read_b32 v26, v23 offset:128
    ds_read_b32 v27, v23 offset:192
    ds_read_b128 v[100:103], v18 offset:0
    ds_read_b128 v[104:107], v18 offset:64
    ds_read_b128 v[108:111], v18 offset:128
    ds_read_b128 v[112:115], v18 offset:192
    ds_read2_b32 v[120:121], v19 offset0:0 offset1:16
    ds_read2_b32 v[122:123], v20 offset0:0 offset1:16
    ds_read_b64_tr_b16 v[60:61], v9 offset:20608
    ds_read_b64_tr_b16 v[62:63], v9 offset:21376
    s_waitcnt lgkmcnt(10)
    buffer_load_dwordx4 v7, s[16:19], s7 offen offset:1024 lds
    ds_read_b64_tr_b16 v[64:65], v10 offset:20640
    ds_read_b64_tr_b16 v[66:67], v10 offset:21408
    buffer_load_dwordx4 v8, s[16:19], s7 offen offset:2048 lds
    v_mfma_f32_16x16x32_bf16 v[76:79], v[248:251], v[44:47], v[76:79]
    ds_read_b64_tr_b16 v[32:33], v12 offset:20576
    v_mfma_f32_16x16x32_bf16 v[80:83], v[252:255], v[44:47], v[80:83]
    ds_read_b64_tr_b16 v[34:35], v12 offset:21344
    s_waitcnt lgkmcnt(10)
    s_add_u32 s53, s54, 3
    s_and_b32 s53, s53, 7
    s_add_u32 m0, s95, 28672
    s_mul_i32 s7, s53, 176128
    buffer_load_dwordx4 v6, s[16:19], s7 offen offset:0 lds
    ds_read_b64_tr_b16 v[36:37], v11 offset:20608
    ds_read_b64_tr_b16 v[38:39], v11 offset:21376
    ds_read_b64_tr_b16 v[40:41], v12 offset:20640
    ds_read_b64_tr_b16 v[42:43], v12 offset:21408
    s_waitcnt lgkmcnt(10)
    s_nop 1
    v_add_f32 v120, v120, v121
    v_add_f32 v122, v122, v123
    v_pk_fma_f32 v[68:69], v[100:101], v[120:121], v[68:69] op_sel_hi:[1,0,1]
    v_pk_fma_f32 v[70:71], v[102:103], v[120:121], v[70:71] op_sel_hi:[1,0,1]
    v_pk_mul_f32 v[68:69], v[68:69], v[104:105]
    v_pk_mul_f32 v[70:71], v[70:71], v[106:107]
    v_pk_fma_f32 v[72:73], v[108:109], v[120:121], v[72:73] op_sel_hi:[1,0,1]
    v_pk_fma_f32 v[74:75], v[110:111], v[120:121], v[74:75] op_sel_hi:[1,0,1]
    v_pk_mul_f32 v[72:73], v[72:73], v[112:113]
    v_pk_mul_f32 v[74:75], v[74:75], v[114:115]
    v_cvt_pk_bf16_f32 v44, v68, v69
    v_cvt_pk_bf16_f32 v45, v70, v71
    v_cvt_pk_bf16_f32 v46, v72, v73
    v_cvt_pk_bf16_f32 v47, v74, v75
    s_nop 1
    v_permlane16_swap_b32 v44, v46
    v_permlane16_swap_b32 v45, v47
    buffer_store_dwordx4 v[44:47], v17, s[20:23], s0 offen sc1
    v_pk_fma_f32 v[76:77], v[100:101], v[122:123], v[76:77] op_sel_hi:[1,0,1]
    v_pk_fma_f32 v[78:79], v[102:103], v[122:123], v[78:79] op_sel_hi:[1,0,1]
    v_pk_mul_f32 v[76:77], v[76:77], v[104:105]
    v_pk_mul_f32 v[78:79], v[78:79], v[106:107]
    v_pk_fma_f32 v[80:81], v[108:109], v[122:123], v[80:81] op_sel_hi:[1,0,1]
    v_pk_fma_f32 v[82:83], v[110:111], v[122:123], v[82:83] op_sel_hi:[1,0,1]
    v_pk_mul_f32 v[80:81], v[80:81], v[112:113]
    v_pk_mul_f32 v[82:83], v[82:83], v[114:115]
    v_cvt_pk_bf16_f32 v48, v76, v77
    v_cvt_pk_bf16_f32 v49, v78, v79
    v_cvt_pk_bf16_f32 v50, v80, v81
    v_cvt_pk_bf16_f32 v51, v82, v83
    s_nop 1
    v_permlane16_swap_b32 v48, v50
    v_permlane16_swap_b32 v49, v51
    buffer_store_dwordx4 v[48:51], v17, s[20:23], s1 offen sc1
    v_lshrrev_b32 v16, 5, v1
    v_bfe_u32 v124, v1, 1, 1
    v_cmp_eq_u32 vcc, v16, v124
    v_mov_b32 v127, s39
    v_and_b32 v16, 1, v1
    v_cndmask_b32 v124, 0, v127, vcc
    v_cndmask_b32 v125, 0, v127, vcc
    v_cndmask_b32 v126, 0, v127, vcc
    v_cndmask_b32 v127, 0, v127, vcc
    v_mul_u32_u24 v16, 0xaaaa, v16
    v_add_u32 v16, 0x4444, v16
    v_mov_b32 v120, 0
    v_mov_b32 v121, 0
    v_mov_b32 v122, 0
    v_mov_b32 v123, 0
    s_waitcnt lgkmcnt(6)
    v_mfma_f32_16x16x32_bf16 v[68:71], v[56:59], v[128:131], 0
    ds_read_b64_tr_b16 v[44:45], v14 offset:20576
    v_mfma_f32_16x16x32_bf16 v[72:75], v[56:59], v[132:135], 0
    ds_read_b64_tr_b16 v[46:47], v14 offset:21344
    buffer_load_dwordx4 v7, s[16:19], s7 offen offset:1024 lds
    v_mfma_f32_16x16x32_bf16 v[76:79], v[60:63], v[128:131], 0
    ds_read_b64_tr_b16 v[48:49], v13 offset:20608
    v_mfma_f32_16x16x32_bf16 v[80:83], v[60:63], v[132:135], 0
    ds_read_b64_tr_b16 v[50:51], v13 offset:21376
    v_mfma_f32_16x16x32_bf16 v[84:87], v[64:67], v[128:131], 0
    ds_read_b64_tr_b16 v[52:53], v14 offset:20640
    ds_read_b64_tr_b16 v[54:55], v14 offset:21408
    v_smfmac_f32_16x16x64_bf16 v[120:123], v[124:127], v[56:63], v16
    v_mfma_f32_16x16x32_bf16 v[28:31], v[116:119], v[64:67], 0
    s_waitcnt lgkmcnt(6)
    v_mfma_f32_16x16x32_bf16 v[92:95], v[32:35], v[128:131], 0
    ds_read_b64_tr_b16 v[56:57], v21 offset:20576
    v_mfma_f32_16x16x32_bf16 v[96:99], v[32:35], v[132:135], 0
    ds_read_b64_tr_b16 v[58:59], v21 offset:21344
    buffer_load_dwordx4 v8, s[16:19], s7 offen offset:2048 lds
    v_mfma_f32_16x16x32_bf16 v[100:103], v[36:39], v[128:131], 0
    ds_read_b64_tr_b16 v[60:61], v15 offset:20608
    v_mfma_f32_16x16x32_bf16 v[104:107], v[36:39], v[132:135], 0
    ds_read_b64_tr_b16 v[62:63], v15 offset:21376
    v_mfma_f32_16x16x32_bf16 v[108:111], v[40:43], v[128:131], 0
    ds_read_b64_tr_b16 v[64:65], v21 offset:20640
    ds_read_b64_tr_b16 v[66:67], v21 offset:21408
    s_waitcnt vmcnt(8)
    s_barrier
    s_waitcnt lgkmcnt(6)
    v_mfma_f32_16x16x32_bf16 v[68:71], v[44:47], v[136:139], v[68:71]
    ds_read_b64_tr_b16 v[32:33], v10 offset:49248
    v_mfma_f32_16x16x32_bf16 v[72:75], v[44:47], v[140:143], v[72:75]
    ds_read_b64_tr_b16 v[34:35], v10 offset:50016
    s_add_u32 s53, s54, 4
    s_and_b32 s53, s53, 7
    s_add_u32 m0, s95, 57344
    s_mul_i32 s7, s53, 176128
    buffer_load_dwordx4 v6, s[16:19], s7 offen offset:0 lds
    v_mfma_f32_16x16x32_bf16 v[76:79], v[48:51], v[136:139], v[76:79]
    ds_read_b64_tr_b16 v[36:37], v9 offset:49280
    v_mfma_f32_16x16x32_bf16 v[80:83], v[48:51], v[140:143], v[80:83]
    ds_read_b64_tr_b16 v[38:39], v9 offset:50048
    v_mfma_f32_16x16x32_bf16 v[84:87], v[52:55], v[136:139], v[84:87]
    ds_read_b64_tr_b16 v[40:41], v10 offset:49312
    ds_read_b64_tr_b16 v[42:43], v10 offset:50080
    s_waitcnt lgkmcnt(6)
    v_mfma_f32_16x16x32_bf16 v[92:95], v[56:59], v[136:139], v[92:95]
    ds_read_b64_tr_b16 v[44:45], v12 offset:49248
    v_mfma_f32_16x16x32_bf16 v[96:99], v[56:59], v[140:143], v[96:99]
    ds_read_b64_tr_b16 v[46:47], v12 offset:50016
    buffer_load_dwordx4 v7, s[16:19], s7 offen offset:1024 lds
    v_mfma_f32_16x16x32_bf16 v[100:103], v[60:63], v[136:139], v[100:103]
    ds_read_b64_tr_b16 v[48:49], v11 offset:49280
    v_mfma_f32_16x16x32_bf16 v[104:107], v[60:63], v[140:143], v[104:107]
    ds_read_b64_tr_b16 v[50:51], v11 offset:50048
    v_and_b32 v19, 27, v1
    v_cmp_eq_u32 vcc, 16, v19
    v_mov_b32 v22, s39
    s_nop 0
    v_cndmask_b32 v19, 0, v22, vcc
    v_cndmask_b32 v18, 0, v22, vcc
    v_mfma_f32_16x16x32_bf16 v[108:111], v[64:67], v[136:139], v[108:111]
    ds_read_b64_tr_b16 v[52:53], v12 offset:49312
    ds_read_b64_tr_b16 v[54:55], v12 offset:50080
    s_waitcnt lgkmcnt(6)
    v_mfma_f32_16x16x32_bf16 v[68:71], v[32:35], v[144:147], v[68:71]
    ds_read_b64_tr_b16 v[56:57], v14 offset:49248
    v_mfma_f32_16x16x32_bf16 v[72:75], v[32:35], v[148:151], v[72:75]
    ds_read_b64_tr_b16 v[58:59], v14 offset:50016
    buffer_load_dwordx4 v8, s[16:19], s7 offen offset:2048 lds
    v_mfma_f32_16x16x32_bf16 v[76:79], v[36:39], v[144:147], v[76:79]
    ds_read_b64_tr_b16 v[60:61], v13 offset:49280
    v_mfma_f32_16x16x32_bf16 v[80:83], v[36:39], v[148:151], v[80:83]
    ds_read_b64_tr_b16 v[62:63], v13 offset:50048
    v_mov_b64 v[128:129], v[18:19]
    v_mfma_f32_16x16x32_bf16 v[84:87], v[40:43], v[144:147], v[84:87]
    ds_read_b64_tr_b16 v[64:65], v14 offset:49312
    ds_read_b64_tr_b16 v[66:67], v14 offset:50080
    v_mov_b64 v[130:131], v[18:19]
    v_smfmac_f32_16x16x64_bf16 v[120:123], v[124:127], v[32:39], v16
    v_mfma_f32_16x16x32_bf16 v[28:31], v[116:119], v[40:43], v[28:31]
    s_waitcnt lgkmcnt(6)
    v_mfma_f32_16x16x32_bf16 v[92:95], v[44:47], v[144:147], v[92:95]
    ds_read_b64_tr_b16 v[32:33], v21 offset:49248
    v_mfma_f32_16x16x32_bf16 v[96:99], v[44:47], v[148:151], v[96:99]
    ds_read_b64_tr_b16 v[34:35], v21 offset:50016
    v_mov_b64 v[132:133], v[18:19]
    v_mfma_f32_16x16x32_bf16 v[100:103], v[48:51], v[144:147], v[100:103]
    ds_read_b64_tr_b16 v[36:37], v15 offset:49280
    v_mfma_f32_16x16x32_bf16 v[104:107], v[48:51], v[148:151], v[104:107]
    ds_read_b64_tr_b16 v[38:39], v15 offset:50048
    v_mov_b64 v[134:135], v[18:19]
    v_mfma_f32_16x16x32_bf16 v[108:111], v[52:55], v[144:147], v[108:111]
    ds_read_b64_tr_b16 v[40:41], v21 offset:49312
    ds_read_b64_tr_b16 v[42:43], v21 offset:50080
    s_waitcnt vmcnt(8)
    s_barrier
    s_waitcnt lgkmcnt(6)
    v_add_u32 v9, 0xffff0000, v9
    v_add_u32 v10, 0xffff0000, v10
    v_mfma_f32_16x16x32_bf16 v[68:71], v[56:59], v[152:155], v[68:71]
    ds_read_b64_tr_b16 v[44:45], v10 offset:96
    v_mfma_f32_16x16x32_bf16 v[72:75], v[56:59], v[156:159], v[72:75]
    ds_read_b64_tr_b16 v[46:47], v10 offset:864
    s_add_u32 s53, s54, 5
    s_and_b32 s53, s53, 7
    s_add_u32 m0, s95, 86016
    s_mul_i32 s7, s53, 176128
    buffer_load_dwordx4 v6, s[16:19], s7 offen offset:0 lds
    v_mfma_f32_16x16x32_bf16 v[76:79], v[60:63], v[152:155], v[76:79]
    ds_read_b64_tr_b16 v[48:49], v9 offset:128
    v_mfma_f32_16x16x32_bf16 v[80:83], v[60:63], v[156:159], v[80:83]
    ds_read_b64_tr_b16 v[50:51], v9 offset:896
    v_mov_b64 v[136:137], v[18:19]
    v_mfma_f32_16x16x32_bf16 v[84:87], v[64:67], v[152:155], v[84:87]
    ds_read_b64_tr_b16 v[52:53], v10 offset:160
    ds_read_b64_tr_b16 v[54:55], v10 offset:928
    v_mov_b64 v[138:139], v[18:19]
    s_waitcnt lgkmcnt(6)
    v_add_u32 v11, 0xffff0000, v11
    v_add_u32 v12, 0xffff0000, v12
    v_mfma_f32_16x16x32_bf16 v[92:95], v[32:35], v[152:155], v[92:95]
    ds_read_b64_tr_b16 v[56:57], v12 offset:96
    v_mfma_f32_16x16x32_bf16 v[96:99], v[32:35], v[156:159], v[96:99]
    ds_read_b64_tr_b16 v[58:59], v12 offset:864
    buffer_load_dwordx4 v7, s[16:19], s7 offen offset:1024 lds
    v_mfma_f32_16x16x32_bf16 v[100:103], v[36:39], v[152:155], v[100:103]
    ds_read_b64_tr_b16 v[60:61], v11 offset:128
    v_mfma_f32_16x16x32_bf16 v[104:107], v[36:39], v[156:159], v[104:107]
    ds_read_b64_tr_b16 v[62:63], v11 offset:896
    v_mov_b64 v[140:141], v[18:19]
    v_mfma_f32_16x16x32_bf16 v[108:111], v[40:43], v[152:155], v[108:111]
    ds_read_b64_tr_b16 v[64:65], v12 offset:160
    ds_read_b64_tr_b16 v[66:67], v12 offset:928
    v_mov_b64 v[142:143], v[18:19]
    s_waitcnt lgkmcnt(6)
    v_add_u32 v13, 0xffff0000, v13
    v_add_u32 v14, 0xffff0000, v14
    v_mfma_f32_16x16x32_bf16 v[68:71], v[44:47], v[160:163], v[68:71]
    ds_read_b64_tr_b16 v[32:33], v14 offset:96
    v_mfma_f32_16x16x32_bf16 v[72:75], v[44:47], v[164:167], v[72:75]
    ds_read_b64_tr_b16 v[34:35], v14 offset:864
    buffer_load_dwordx4 v8, s[16:19], s7 offen offset:2048 lds
    v_mfma_f32_16x16x32_bf16 v[76:79], v[48:51], v[160:163], v[76:79]
    ds_read_b64_tr_b16 v[36:37], v13 offset:128
    v_mfma_f32_16x16x32_bf16 v[80:83], v[48:51], v[164:167], v[80:83]
    ds_read_b64_tr_b16 v[38:39], v13 offset:896
    v_mov_b64 v[144:145], v[18:19]
    v_mfma_f32_16x16x32_bf16 v[84:87], v[52:55], v[160:163], v[84:87]
    ds_read_b64_tr_b16 v[40:41], v14 offset:160
    ds_read_b64_tr_b16 v[42:43], v14 offset:928
    v_mov_b64 v[146:147], v[18:19]
    v_smfmac_f32_16x16x64_bf16 v[120:123], v[124:127], v[44:51], v16
    v_mfma_f32_16x16x32_bf16 v[28:31], v[116:119], v[52:55], v[28:31]
    s_waitcnt lgkmcnt(6)
    v_add_u32 v15, 0xffff0000, v15
    v_add_u32 v21, 0xffff0000, v21
    v_mfma_f32_16x16x32_bf16 v[92:95], v[56:59], v[160:163], v[92:95]
    ds_read_b64_tr_b16 v[44:45], v21 offset:96
    v_mfma_f32_16x16x32_bf16 v[96:99], v[56:59], v[164:167], v[96:99]
    ds_read_b64_tr_b16 v[46:47], v21 offset:864
    v_mov_b64 v[148:149], v[18:19]
    v_mfma_f32_16x16x32_bf16 v[100:103], v[60:63], v[160:163], v[100:103]
    ds_read_b64_tr_b16 v[48:49], v15 offset:128
    v_mfma_f32_16x16x32_bf16 v[104:107], v[60:63], v[164:167], v[104:107]
    ds_read_b64_tr_b16 v[50:51], v15 offset:896
    v_mov_b64 v[150:151], v[18:19]
    v_mfma_f32_16x16x32_bf16 v[108:111], v[64:67], v[160:163], v[108:111]
    ds_read_b64_tr_b16 v[52:53], v21 offset:160
    ds_read_b64_tr_b16 v[54:55], v21 offset:928
    s_waitcnt vmcnt(6)
    s_barrier
    s_lshl_b32 s48, s43, 4
    s_add_u32 s48, s48, s42
    s_lshl_b32 s48, s48, 8
    s_add_u32 s51, s48, 14680064
    s_waitcnt lgkmcnt(6)
    v_mfma_f32_16x16x32_bf16 v[68:71], v[32:35], v[168:171], v[68:71]
    ds_read_b64_tr_b16 v[56:57], v10 offset:28768
    v_mfma_f32_16x16x32_bf16 v[72:75], v[32:35], v[172:175], v[72:75]
    ds_read_b64_tr_b16 v[58:59], v10 offset:29536
    s_add_u32 s53, s54, 6
    s_and_b32 s53, s53, 7
    s_add_u32 m0, s95, 114688
    s_mul_i32 s7, s53, 176128
    buffer_load_dwordx4 v6, s[16:19], s7 offen offset:0 lds
    v_mfma_f32_16x16x32_bf16 v[76:79], v[36:39], v[168:171], v[76:79]
    ds_read_b64_tr_b16 v[60:61], v9 offset:28800
    v_mfma_f32_16x16x32_bf16 v[80:83], v[36:39], v[172:175], v[80:83]
    ds_read_b64_tr_b16 v[62:63], v9 offset:29568
    v_mov_b64 v[152:153], v[18:19]
    v_mfma_f32_16x16x32_bf16 v[84:87], v[40:43], v[168:171], v[84:87]
    ds_read_b64_tr_b16 v[64:65], v10 offset:28832
    ds_read_b64_tr_b16 v[66:67], v10 offset:29600
    v_mov_b64 v[154:155], v[18:19]
    s_waitcnt lgkmcnt(6)
    v_mfma_f32_16x16x32_bf16 v[92:95], v[44:47], v[168:171], v[92:95]
    ds_read_b64_tr_b16 v[32:33], v12 offset:28768
    v_mfma_f32_16x16x32_bf16 v[96:99], v[44:47], v[172:175], v[96:99]
    ds_read_b64_tr_b16 v[34:35], v12 offset:29536
    buffer_load_dwordx4 v7, s[16:19], s7 offen offset:1024 lds
    v_mfma_f32_16x16x32_bf16 v[100:103], v[48:51], v[168:171], v[100:103]
    ds_read_b64_tr_b16 v[36:37], v11 offset:28800
    v_mfma_f32_16x16x32_bf16 v[104:107], v[48:51], v[172:175], v[104:107]
    ds_read_b64_tr_b16 v[38:39], v11 offset:29568
    v_mov_b64 v[156:157], v[18:19]
    v_mfma_f32_16x16x32_bf16 v[108:111], v[52:55], v[168:171], v[108:111]
    ds_read_b64_tr_b16 v[40:41], v12 offset:28832
    ds_read_b64_tr_b16 v[42:43], v12 offset:29600
    v_mov_b64 v[158:159], v[18:19]
    s_waitcnt lgkmcnt(6)
    v_mfma_f32_16x16x32_bf16 v[68:71], v[56:59], v[176:179], v[68:71]
    ds_read_b64_tr_b16 v[44:45], v14 offset:28768
    v_mfma_f32_16x16x32_bf16 v[72:75], v[56:59], v[180:183], v[72:75]
    ds_read_b64_tr_b16 v[46:47], v14 offset:29536
    buffer_load_dwordx4 v8, s[16:19], s7 offen offset:2048 lds
    v_mfma_f32_16x16x32_bf16 v[76:79], v[60:63], v[176:179], v[76:79]
    ds_read_b64_tr_b16 v[48:49], v13 offset:28800
    v_mfma_f32_16x16x32_bf16 v[80:83], v[60:63], v[180:183], v[80:83]
    ds_read_b64_tr_b16 v[50:51], v13 offset:29568
    v_mov_b64 v[160:161], v[18:19]
    v_mfma_f32_16x16x32_bf16 v[84:87], v[64:67], v[176:179], v[84:87]
    ds_read_b64_tr_b16 v[52:53], v14 offset:28832
    ds_read_b64_tr_b16 v[54:55], v14 offset:29600
    v_mov_b64 v[162:163], v[18:19]
    v_smfmac_f32_16x16x64_bf16 v[120:123], v[124:127], v[56:63], v16
    v_mfma_f32_16x16x32_bf16 v[28:31], v[116:119], v[64:67], v[28:31]
    s_waitcnt lgkmcnt(6)
    v_mfma_f32_16x16x32_bf16 v[92:95], v[32:35], v[176:179], v[92:95]
    ds_read_b64_tr_b16 v[56:57], v21 offset:28768
    v_mfma_f32_16x16x32_bf16 v[96:99], v[32:35], v[180:183], v[96:99]
    ds_read_b64_tr_b16 v[58:59], v21 offset:29536
    v_mov_b64 v[164:165], v[18:19]
    v_mfma_f32_16x16x32_bf16 v[100:103], v[36:39], v[176:179], v[100:103]
    ds_read_b64_tr_b16 v[60:61], v15 offset:28800
    v_mfma_f32_16x16x32_bf16 v[104:107], v[36:39], v[180:183], v[104:107]
    ds_read_b64_tr_b16 v[62:63], v15 offset:29568
    v_mov_b64 v[166:167], v[18:19]
    v_mfma_f32_16x16x32_bf16 v[108:111], v[40:43], v[176:179], v[108:111]
    ds_read_b64_tr_b16 v[64:65], v21 offset:28832
    ds_read_b64_tr_b16 v[66:67], v21 offset:29600
    s_waitcnt vmcnt(6)
    s_barrier
    s_waitcnt lgkmcnt(6)
    v_mfma_f32_16x16x32_bf16 v[68:71], v[44:47], v[184:187], v[68:71]
    ds_read_b64_tr_b16 v[32:33], v10 offset:57440
    v_mfma_f32_16x16x32_bf16 v[72:75], v[44:47], v[188:191], v[72:75]
    ds_read_b64_tr_b16 v[34:35], v10 offset:58208
    s_add_u32 s53, s54, 7
    s_and_b32 s53, s53, 7
    s_add_u32 m0, s95, 0
    s_mul_i32 s7, s53, 176128
    buffer_load_dwordx4 v6, s[16:19], s7 offen offset:0 lds
    v_mfma_f32_16x16x32_bf16 v[76:79], v[48:51], v[184:187], v[76:79]
    ds_read_b64_tr_b16 v[36:37], v9 offset:57472
    v_mfma_f32_16x16x32_bf16 v[80:83], v[48:51], v[188:191], v[80:83]
    ds_read_b64_tr_b16 v[38:39], v9 offset:58240
    v_lshlrev_b32 v2, 4, v1
    v_and_b32 v3, 15, v1
    v_lshlrev_b32 v3, 4, v3
    v_lshrrev_b32 v22, 5, v1
    v_lshl_add_u32 v3, v22, 8, v3
    v_mfma_f32_16x16x32_bf16 v[84:87], v[52:55], v[184:187], v[84:87]
    ds_read_b64_tr_b16 v[40:41], v10 offset:57504
    ds_read_b64_tr_b16 v[42:43], v10 offset:58272
    v_mov_b64 v[168:169], v[18:19]
    v_mov_b64 v[170:171], v[18:19]
    s_waitcnt lgkmcnt(6)
    v_mfma_f32_16x16x32_bf16 v[92:95], v[56:59], v[184:187], v[92:95]
    ds_read_b64_tr_b16 v[44:45], v12 offset:57440
    v_mfma_f32_16x16x32_bf16 v[96:99], v[56:59], v[188:191], v[96:99]
    ds_read_b64_tr_b16 v[46:47], v12 offset:58208
    buffer_load_dwordx4 v7, s[16:19], s7 offen offset:1024 lds
    v_mfma_f32_16x16x32_bf16 v[100:103], v[60:63], v[184:187], v[100:103]
    ds_read_b64_tr_b16 v[48:49], v11 offset:57472
    v_mfma_f32_16x16x32_bf16 v[104:107], v[60:63], v[188:191], v[104:107]
    ds_read_b64_tr_b16 v[50:51], v11 offset:58240
    v_mov_b64 v[172:173], v[18:19]
    v_mfma_f32_16x16x32_bf16 v[108:111], v[64:67], v[184:187], v[108:111]
    ds_read_b64_tr_b16 v[52:53], v12 offset:57504
    ds_read_b64_tr_b16 v[54:55], v12 offset:58272
    v_mov_b64 v[174:175], v[18:19]
    s_waitcnt lgkmcnt(6)
    v_mfma_f32_16x16x32_bf16 v[68:71], v[32:35], v[192:195], v[68:71]
    ds_read_b64_tr_b16 v[56:57], v14 offset:57440
    v_mfma_f32_16x16x32_bf16 v[72:75], v[32:35], v[196:199], v[72:75]
    ds_read_b64_tr_b16 v[58:59], v14 offset:58208
    buffer_load_dwordx4 v8, s[16:19], s7 offen offset:2048 lds
    v_mfma_f32_16x16x32_bf16 v[76:79], v[36:39], v[192:195], v[76:79]
    ds_read_b64_tr_b16 v[60:61], v13 offset:57472
    v_mfma_f32_16x16x32_bf16 v[80:83], v[36:39], v[196:199], v[80:83]
    ds_read_b64_tr_b16 v[62:63], v13 offset:58240
    v_mov_b64 v[176:177], v[18:19]
    v_mfma_f32_16x16x32_bf16 v[84:87], v[40:43], v[192:195], v[84:87]
    ds_read_b64_tr_b16 v[64:65], v14 offset:57504
    ds_read_b64_tr_b16 v[66:67], v14 offset:58272
    v_mov_b64 v[178:179], v[18:19]
    v_smfmac_f32_16x16x64_bf16 v[120:123], v[124:127], v[32:39], v16
    v_mfma_f32_16x16x32_bf16 v[28:31], v[116:119], v[40:43], v[28:31]
    s_waitcnt lgkmcnt(6)
    v_mfma_f32_16x16x32_bf16 v[92:95], v[44:47], v[192:195], v[92:95]
    ds_read_b64_tr_b16 v[32:33], v21 offset:57440
    v_mfma_f32_16x16x32_bf16 v[96:99], v[44:47], v[196:199], v[96:99]
    ds_read_b64_tr_b16 v[34:35], v21 offset:58208
    v_mov_b64 v[180:181], v[18:19]
    v_mfma_f32_16x16x32_bf16 v[100:103], v[48:51], v[192:195], v[100:103]
    ds_read_b64_tr_b16 v[36:37], v15 offset:57472
    v_mfma_f32_16x16x32_bf16 v[104:107], v[48:51], v[196:199], v[104:107]
    ds_read_b64_tr_b16 v[38:39], v15 offset:58240
    v_mov_b64 v[182:183], v[18:19]
    v_mfma_f32_16x16x32_bf16 v[108:111], v[52:55], v[192:195], v[108:111]
    ds_read_b64_tr_b16 v[40:41], v21 offset:57504
    ds_read_b64_tr_b16 v[42:43], v21 offset:58272
    s_waitcnt vmcnt(6)
    s_barrier
    s_waitcnt lgkmcnt(6)
    v_add_u32 v9, 0x10000, v9
    v_add_u32 v10, 0x10000, v10
    v_mfma_f32_16x16x32_bf16 v[68:71], v[56:59], v[200:203], v[68:71]
    ds_read_b64_tr_b16 v[44:45], v10 offset:20576
    v_mfma_f32_16x16x32_bf16 v[72:75], v[56:59], v[204:207], v[72:75]
    ds_read_b64_tr_b16 v[46:47], v10 offset:21344
    v_mov_b64 v[184:185], v[18:19]
    v_mfma_f32_16x16x32_bf16 v[76:79], v[60:63], v[200:203], v[76:79]
    ds_read_b64_tr_b16 v[48:49], v9 offset:20608
    v_mfma_f32_16x16x32_bf16 v[80:83], v[60:63], v[204:207], v[80:83]
    ds_read_b64_tr_b16 v[50:51], v9 offset:21376
    v_mov_b64 v[186:187], v[18:19]
    v_mfma_f32_16x16x32_bf16 v[84:87], v[64:67], v[200:203], v[84:87]
    ds_read_b64_tr_b16 v[52:53], v10 offset:20640
    ds_read_b64_tr_b16 v[54:55], v10 offset:21408
    s_mov_b64 exec, 0x3f
    buffer_load_dword v5, v0, s[20:23], 0 offen sc1
    s_mov_b64 exec, -1
    s_waitcnt lgkmcnt(6)
    v_add_u32 v11, 0x10000, v11
    v_add_u32 v12, 0x10000, v12
    v_mfma_f32_16x16x32_bf16 v[92:95], v[32:35], v[200:203], v[92:95]
    ds_read_b64_tr_b16 v[56:57], v12 offset:20576
    v_mfma_f32_16x16x32_bf16 v[96:99], v[32:35], v[204:207], v[96:99]
    ds_read_b64_tr_b16 v[58:59], v12 offset:21344
    v_mov_b64 v[188:189], v[18:19]
    v_mfma_f32_16x16x32_bf16 v[100:103], v[36:39], v[200:203], v[100:103]
    ds_read_b64_tr_b16 v[60:61], v11 offset:20608
    v_mfma_f32_16x16x32_bf16 v[104:107], v[36:39], v[204:207], v[104:107]
    ds_read_b64_tr_b16 v[62:63], v11 offset:21376
    v_mov_b64 v[190:191], v[18:19]
    v_mfma_f32_16x16x32_bf16 v[108:111], v[40:43], v[200:203], v[108:111]
    ds_read_b64_tr_b16 v[64:65], v12 offset:20640
    ds_read_b64_tr_b16 v[66:67], v12 offset:21408
    s_waitcnt lgkmcnt(6)
    v_add_u32 v13, 0x10000, v13
    v_add_u32 v14, 0x10000, v14
    v_mfma_f32_16x16x32_bf16 v[68:71], v[44:47], v[208:211], v[68:71]
    ds_read_b64_tr_b16 v[32:33], v14 offset:20576
    v_mfma_f32_16x16x32_bf16 v[72:75], v[44:47], v[212:215], v[72:75]
    ds_read_b64_tr_b16 v[34:35], v14 offset:21344
    v_mfma_f32_16x16x32_bf16 v[76:79], v[48:51], v[208:211], v[76:79]
    ds_read_b64_tr_b16 v[36:37], v13 offset:20608
    v_mfma_f32_16x16x32_bf16 v[80:83], v[48:51], v[212:215], v[80:83]
    ds_read_b64_tr_b16 v[38:39], v13 offset:21376
    v_mfma_f32_16x16x32_bf16 v[84:87], v[52:55], v[208:211], v[84:87]
    ds_read_b64_tr_b16 v[40:41], v14 offset:20640
    ds_read_b64_tr_b16 v[42:43], v14 offset:21408
    v_smfmac_f32_16x16x64_bf16 v[120:123], v[124:127], v[44:51], v16
    v_mfma_f32_16x16x32_bf16 v[28:31], v[116:119], v[52:55], v[28:31]
    s_waitcnt vmcnt(0)
    s_mov_b64 exec, 0x3f
    v_cmp_ne_u32 vcc, s3, v5
    s_mov_b32 s79, 20000
    s_cbranch_vccz L_pok_7
L_psp_8:
    s_sleep 8
    buffer_load_dword v5, v0, s[20:23], 0 offen sc1
    s_sub_u32 s79, s79, 1
    s_waitcnt vmcnt(0)
    v_cmp_ne_u32 vcc, s3, v5
    s_cmp_eq_u32 s79, 0
    s_cbranch_scc1 L_pok_7
    s_cbranch_vccnz L_psp_8
L_pok_7:
    s_mov_b64 exec, -1
    s_waitcnt lgkmcnt(6)
    v_add_u32 v15, 0x10000, v15
    v_add_u32 v21, 0x10000, v21
    v_mfma_f32_16x16x32_bf16 v[92:95], v[56:59], v[208:211], v[92:95]
    ds_read_b64_tr_b16 v[44:45], v21 offset:20576
    v_mfma_f32_16x16x32_bf16 v[96:99], v[56:59], v[212:215], v[96:99]
    ds_read_b64_tr_b16 v[46:47], v21 offset:21344
    buffer_load_dwordx4 v[192:195], v2, s[20:23], s58 offen offset:0 sc1
    v_mfma_f32_16x16x32_bf16 v[100:103], v[60:63], v[208:211], v[100:103]
    ds_read_b64_tr_b16 v[48:49], v15 offset:20608
    v_mfma_f32_16x16x32_bf16 v[104:107], v[60:63], v[212:215], v[104:107]
    ds_read_b64_tr_b16 v[50:51], v15 offset:21376
    v_mfma_f32_16x16x32_bf16 v[108:111], v[64:67], v[208:211], v[108:111]
    ds_read_b64_tr_b16 v[52:53], v21 offset:20640
    ds_read_b64_tr_b16 v[54:55], v21 offset:21408
    s_waitcnt vmcnt(5)
    s_barrier
    s_waitcnt lgkmcnt(6)
    v_mfma_f32_16x16x32_bf16 v[68:71], v[32:35], v[216:219], v[68:71]
    ds_read_b64_tr_b16 v[56:57], v10 offset:49248
    v_mfma_f32_16x16x32_bf16 v[72:75], v[32:35], v[220:223], v[72:75]
    ds_read_b64_tr_b16 v[58:59], v10 offset:50016
    s_mov_b32 exec_lo, 0xffff
    s_mov_b32 exec_hi, 0xffff
    buffer_load_dwordx4 v[128:131], v3, s[20:23], s60 offen offset:0 sc1
    buffer_load_dwordx4 v[132:135], v3, s[20:23], s60 offen offset:512 sc1
    s_mov_b64 exec, -1
    v_mfma_f32_16x16x32_bf16 v[76:79], v[36:39], v[216:219], v[76:79]
    ds_read_b64_tr_b16 v[60:61], v9 offset:49280
    v_mfma_f32_16x16x32_bf16 v[80:83], v[36:39], v[220:223], v[80:83]
    ds_read_b64_tr_b16 v[62:63], v9 offset:50048
    v_mfma_f32_16x16x32_bf16 v[84:87], v[40:43], v[216:219], v[84:87]
    ds_read_b64_tr_b16 v[64:65], v10 offset:49312
    ds_read_b64_tr_b16 v[66:67], v10 offset:50080
    s_waitcnt lgkmcnt(6)
    v_mfma_f32_16x16x32_bf16 v[92:95], v[44:47], v[216:219], v[92:95]
    ds_read_b64_tr_b16 v[32:33], v12 offset:49248
    v_mfma_f32_16x16x32_bf16 v[96:99], v[44:47], v[220:223], v[96:99]
    ds_read_b64_tr_b16 v[34:35], v12 offset:50016
    buffer_load_dwordx4 v[196:199], v2, s[20:23], s58 offen offset:1024 sc1
    v_mfma_f32_16x16x32_bf16 v[100:103], v[48:51], v[216:219], v[100:103]
    ds_read_b64_tr_b16 v[36:37], v11 offset:49280
    v_mfma_f32_16x16x32_bf16 v[104:107], v[48:51], v[220:223], v[104:107]
    ds_read_b64_tr_b16 v[38:39], v11 offset:50048
    v_mfma_f32_16x16x32_bf16 v[108:111], v[52:55], v[216:219], v[108:111]
    ds_read_b64_tr_b16 v[40:41], v12 offset:49312
    ds_read_b64_tr_b16 v[42:43], v12 offset:50080
    s_waitcnt lgkmcnt(6)
    v_mfma_f32_16x16x32_bf16 v[68:71], v[56:59], v[224:227], v[68:71]
    ds_read_b64_tr_b16 v[44:45], v14 offset:49248
    v_mfma_f32_16x16x32_bf16 v[72:75], v[56:59], v[228:231], v[72:75]
    ds_read_b64_tr_b16 v[46:47], v14 offset:50016
    s_mov_b32 exec_lo, 0xffff
    s_mov_b32 exec_hi, 0xffff
    buffer_load_dwordx4 v[136:139], v3, s[20:23], s60 offen offset:1024 sc1
    buffer_load_dwordx4 v[140:143], v3, s[20:23], s60 offen offset:1536 sc1
    s_mov_b64 exec, -1
    v_mfma_f32_16x16x32_bf16 v[76:79], v[60:63], v[224:227], v[76:79]
    ds_read_b64_tr_b16 v[48:49], v13 offset:49280
    v_mfma_f32_16x16x32_bf16 v[80:83], v[60:63], v[228:231], v[80:83]
    ds_read_b64_tr_b16 v[50:51], v13 offset:50048
    v_mfma_f32_16x16x32_bf16 v[84:87], v[64:67], v[224:227], v[84:87]
    ds_read_b64_tr_b16 v[52:53], v14 offset:49312
    ds_read_b64_tr_b16 v[54:55], v14 offset:50080
    v_smfmac_f32_16x16x64_bf16 v[120:123], v[124:127], v[56:63], v16
    v_mfma_f32_16x16x32_bf16 v[28:31], v[116:119], v[64:67], v[28:31]
    s_waitcnt lgkmcnt(6)
    v_mfma_f32_16x16x32_bf16 v[92:95], v[32:35], v[224:227], v[92:95]
    ds_read_b64_tr_b16 v[56:57], v21 offset:49248
    v_mfma_f32_16x16x32_bf16 v[96:99], v[32:35], v[228:231], v[96:99]
    ds_read_b64_tr_b16 v[58:59], v21 offset:50016
    buffer_load_dwordx4 v[200:203], v2, s[20:23], s58 offen offset:2048 sc1
    v_mfma_f32_16x16x32_bf16 v[100:103], v[36:39], v[224:227], v[100:103]
    ds_read_b64_tr_b16 v[60:61], v15 offset:49280
    v_mfma_f32_16x16x32_bf16 v[104:107], v[36:39], v[228:231], v[104:107]
    ds_read_b64_tr_b16 v[62:63], v15 offset:50048
    v_mfma_f32_16x16x32_bf16 v[108:111], v[40:43], v[224:227], v[108:111]
    ds_read_b64_tr_b16 v[64:65], v21 offset:49312
    ds_read_b64_tr_b16 v[66:67], v21 offset:50080
    s_waitcnt vmcnt(8)
    s_barrier
    s_waitcnt lgkmcnt(6)
    v_add_u32 v9, 0xffff0000, v9
    v_add_u32 v10, 0xffff0000, v10
    v_mfma_f32_16x16x32_bf16 v[68:71], v[44:47], v[232:235], v[68:71]
    ds_read_b64_tr_b16 v[32:33], v10 offset:96
    v_mfma_f32_16x16x32_bf16 v[72:75], v[44:47], v[236:239], v[72:75]
    ds_read_b64_tr_b16 v[34:35], v10 offset:864
    buffer_load_dwordx4 v[224:227], v2, s[20:23], s64 offen sc1
    v_mfma_f32_16x16x32_bf16 v[76:79], v[48:51], v[232:235], v[76:79]
    ds_read_b64_tr_b16 v[36:37], v9 offset:128
    v_mfma_f32_16x16x32_bf16 v[80:83], v[48:51], v[236:239], v[80:83]
    ds_read_b64_tr_b16 v[38:39], v9 offset:896
    v_mfma_f32_16x16x32_bf16 v[84:87], v[52:55], v[232:235], v[84:87]
    ds_read_b64_tr_b16 v[40:41], v10 offset:160
    ds_read_b64_tr_b16 v[42:43], v10 offset:928
    s_waitcnt lgkmcnt(6)
    v_add_u32 v11, 0xffff0000, v11
    v_add_u32 v12, 0xffff0000, v12
    v_mfma_f32_16x16x32_bf16 v[92:95], v[56:59], v[232:235], v[92:95]
    ds_read_b64_tr_b16 v[44:45], v12 offset:96
    v_mfma_f32_16x16x32_bf16 v[96:99], v[56:59], v[236:239], v[96:99]
    ds_read_b64_tr_b16 v[46:47], v12 offset:864
    s_mov_b32 exec_lo, 0xffff
    s_mov_b32 exec_hi, 0xffff
    buffer_load_dwordx4 v[144:147], v3, s[20:23], s60 offen offset:2048 sc1
    buffer_load_dwordx4 v[148:151], v3, s[20:23], s60 offen offset:2560 sc1
    s_mov_b64 exec, -1
    v_mfma_f32_16x16x32_bf16 v[100:103], v[60:63], v[232:235], v[100:103]
    ds_read_b64_tr_b16 v[48:49], v11 offset:128
    v_mfma_f32_16x16x32_bf16 v[104:107], v[60:63], v[236:239], v[104:107]
    ds_read_b64_tr_b16 v[50:51], v11 offset:896
    v_mfma_f32_16x16x32_bf16 v[108:111], v[64:67], v[232:235], v[108:111]
    ds_read_b64_tr_b16 v[52:53], v12 offset:160
    ds_read_b64_tr_b16 v[54:55], v12 offset:928
    s_waitcnt lgkmcnt(6)
    v_add_u32 v13, 0xffff0000, v13
    v_add_u32 v14, 0xffff0000, v14
    v_mfma_f32_16x16x32_bf16 v[68:71], v[32:35], v[240:243], v[68:71]
    ds_read_b64_tr_b16 v[56:57], v14 offset:96
    v_mfma_f32_16x16x32_bf16 v[72:75], v[32:35], v[244:247], v[72:75]
    ds_read_b64_tr_b16 v[58:59], v14 offset:864
    buffer_load_dwordx4 v[204:207], v2, s[20:23], s58 offen offset:3072 sc1
    v_mfma_f32_16x16x32_bf16 v[76:79], v[36:39], v[240:243], v[76:79]
    ds_read_b64_tr_b16 v[60:61], v13 offset:128
    v_mfma_f32_16x16x32_bf16 v[80:83], v[36:39], v[244:247], v[80:83]
    ds_read_b64_tr_b16 v[62:63], v13 offset:896
    v_mfma_f32_16x16x32_bf16 v[84:87], v[40:43], v[240:243], v[84:87]
    ds_read_b64_tr_b16 v[64:65], v14 offset:160
    ds_read_b64_tr_b16 v[66:67], v14 offset:928
    v_smfmac_f32_16x16x64_bf16 v[120:123], v[124:127], v[32:39], v16
    v_mfma_f32_16x16x32_bf16 v[28:31], v[116:119], v[40:43], v[28:31]
    s_and_b32 s50, s37, 1
    s_lshl_b32 s50, s50, 7
    s_lshr_b32 s48, s37, 1
    s_lshl_b32 s48, s48, 6
    s_add_u32 s48, s48, s50
    s_add_u32 s48, s48, 158464
    v_and_b32 v18, 15, v1
    v_lshl_add_u32 v18, v18, 2, s48
    s_nop 2
    v_add_f32 v120, v120, v121
    v_add_f32 v121, v122, v123
    ds_write_b32 v18, v120 offset:0
    ds_write_b32 v18, v121 offset:256
    s_waitcnt lgkmcnt(10)
    ds_write_b32 v18, v28 offset:512
    s_waitcnt lgkmcnt(9)
    v_add_u32 v15, 0xffff0000, v15
    v_add_u32 v21, 0xffff0000, v21
    v_mfma_f32_16x16x32_bf16 v[92:95], v[44:47], v[240:243], v[92:95]
    ds_read_b64_tr_b16 v[32:33], v21 offset:96
    v_mfma_f32_16x16x32_bf16 v[96:99], v[44:47], v[244:247], v[96:99]
    ds_read_b64_tr_b16 v[34:35], v21 offset:864
    s_mov_b32 exec_lo, 0xffff
    s_mov_b32 exec_hi, 0xffff
    buffer_load_dwordx4 v[152:155], v3, s[20:23], s60 offen offset:3072 sc1
    buffer_load_dwordx4 v[156:159], v3, s[20:23], s60 offen offset:3584 sc1
    s_mov_b64 exec, -1
    v_mfma_f32_16x16x32_bf16 v[100:103], v[48:51], v[240:243], v[100:103]
    ds_read_b64_tr_b16 v[36:37], v15 offset:128
    v_mfma_f32_16x16x32_bf16 v[104:107], v[48:51], v[244:247], v[104:107]
    ds_read_b64_tr_b16 v[38:39], v15 offset:896
    v_mfma_f32_16x16x32_bf16 v[108:111], v[52:55], v[240:243], v[108:111]
    ds_read_b64_tr_b16 v[40:41], v21 offset:160
    s_waitcnt lgkmcnt(10)
    ds_read_b64_tr_b16 v[42:43], v21 offset:928
    s_waitcnt lgkmcnt(6)
    s_barrier
    v_mfma_f32_16x16x32_bf16 v[68:71], v[56:59], v[248:251], v[68:71]
    v_mfma_f32_16x16x32_bf16 v[72:75], v[56:59], v[252:255], v[72:75]
    s_add_u32 s48, s50, 158464
    v_lshrrev_b32 v6, 4, v1
    v_lshl_add_u32 v6, v6, 4, s48
    v_xor_b32 v7, 0x80, v6
    ds_read_b128 v[8:11], v6 offset:0
    ds_read_b128 v[44:47], v6 offset:64
    ds_read_b128 v[12:15], v6 offset:256
    ds_read_b128 v[48:51], v6 offset:320
    ds_read_b128 v[16:19], v6 offset:512
    ds_read_b128 v[52:55], v6 offset:576
    ds_read_b128 v[20:23], v7 offset:0
    ds_read_b128 v[116:119], v7 offset:64
    s_waitcnt lgkmcnt(10)
    ds_read_b128 v[232:235], v7 offset:256
    ds_read_b128 v[120:123], v7 offset:320
    ds_read_b128 v[236:239], v7 offset:512
    ds_read_b128 v[124:127], v7 offset:576
    s_waitcnt lgkmcnt(10)
    v_mfma_f32_16x16x32_bf16 v[76:79], v[60:63], v[248:251], v[76:79]
    v_mfma_f32_16x16x32_bf16 v[80:83], v[60:63], v[252:255], v[80:83]
    buffer_load_dwordx4 v[208:211], v2, s[20:23], s59 offen offset:0 sc1
    v_mfma_f32_16x16x32_bf16 v[84:87], v[64:67], v[248:251], v[84:87]
    v_mfma_f32_16x16x32_bf16 v[92:95], v[32:35], v[248:251], v[92:95]
    v_mfma_f32_16x16x32_bf16 v[96:99], v[32:35], v[252:255], v[96:99]
    s_mov_b32 exec_lo, 0xffff
    s_mov_b32 exec_hi, 0xffff
    buffer_load_dwordx4 v[160:163], v3, s[20:23], s61 offen offset:0 sc1
    buffer_load_dwordx4 v[164:167], v3, s[20:23], s61 offen offset:512 sc1
    s_mov_b64 exec, -1
    v_mfma_f32_16x16x32_bf16 v[100:103], v[36:39], v[248:251], v[100:103]
    v_mfma_f32_16x16x32_bf16 v[104:107], v[36:39], v[252:255], v[104:107]
    v_mfma_f32_16x16x32_bf16 v[108:111], v[40:43], v[248:251], v[108:111]
    s_setprio 3
    s_cmp_eq_u32 s50, 0
    s_cselect_b32 s48, 0xbfb8aa3b, 0
    s_cselect_b32 s49, 0, 0xbfb8aa3b
    v_mul_f32 v240, s48, v25
    v_mul_f32 v242, s48, v27
    v_mul_f32 v244, s49, v25
    v_mul_f32 v246, s49, v27
    v_mul_f32 v4, v25, v25
    v_mul_f32 v6, v27, v27
    v_rcp_f32 v4, v4
    v_rcp_f32 v6, v6
    s_lshl_b32 s52, s42, 2
    s_add_u32 s52, s52, s37
    s_mul_i32 s52, s52, 86
    s_lshr_b32 s53, s43, 1
    s_mul_i32 s53, s53, 11
    s_cmp_eq_u32 s55, 0
    s_cselect_b32 s48, 3, 7
    s_cselect_b32 s49, 1, -1
    s_add_u32 s53, s53, s48
    s_add_u32 s48, s52, s53
    s_lshl_b32 s48, s48, 10
    s_add_u32 s48, s48, 8388608
    s_cmp_lt_u32 s53, 86
    s_cselect_b32 s88, s48, 0x80000000
    s_add_u32 s53, s53, s49
    s_add_u32 s48, s52, s53
    s_lshl_b32 s48, s48, 10
    s_add_u32 s48, s48, 8388608
    s_cmp_lt_u32 s53, 86
    s_cselect_b32 s89, s48, 0x80000000
    s_add_u32 s53, s53, s49
    s_add_u32 s48, s52, s53
    s_lshl_b32 s48, s48, 10
    s_add_u32 s48, s48, 8388608
    s_cmp_lt_u32 s53, 86
    s_cselect_b32 s90, s48, 0x80000000
    s_add_u32 s53, s53, s49
    s_lshl_b32 s48, s55, 8
    v_xor_b32 v30, s48, v2
    v_and_b32 v31, 0x2f0, v2
    v_bfe_u32 v32, v1, 4, 1
    v_lshl_add_u32 v31, v32, 3, v31
    v_add_u32 v31, s48, v31
    s_waitcnt lgkmcnt(0)
    v_pk_add_f32 v[8:9], v[8:9], v[44:45]
    v_pk_add_f32 v[10:11], v[10:11], v[46:47]
    v_pk_add_f32 v[12:13], v[12:13], v[48:49]
    v_pk_add_f32 v[14:15], v[14:15], v[50:51]
    v_pk_add_f32 v[16:17], v[16:17], v[52:53]
    v_pk_add_f32 v[18:19], v[18:19], v[54:55]
    v_pk_add_f32 v[20:21], v[20:21], v[116:117]
    v_pk_add_f32 v[22:23], v[22:23], v[118:119]
    v_pk_add_f32 v[232:233], v[232:233], v[120:121]
    v_pk_add_f32 v[234:235], v[234:235], v[122:123]
    v_pk_add_f32 v[236:237], v[236:237], v[124:125]
    v_pk_add_f32 v[238:239], v[238:239], v[126:127]
    v_pk_fma_f32 v[68:69], v[8:9], v[24:25], v[68:69] op_sel_hi:[1,0,1]
    v_pk_fma_f32 v[92:93], v[20:21], v[24:25], v[92:93] op_sel_hi:[1,0,1]
    v_pk_fma_f32 v[70:71], v[10:11], v[24:25], v[70:71] op_sel_hi:[1,0,1]
    v_pk_fma_f32 v[94:95], v[22:23], v[24:25], v[94:95] op_sel_hi:[1,0,1]
    v_pk_fma_f32 v[72:73], v[8:9], v[26:27], v[72:73] op_sel_hi:[1,0,1]
    v_pk_fma_f32 v[96:97], v[20:21], v[26:27], v[96:97] op_sel_hi:[1,0,1]
    v_pk_fma_f32 v[74:75], v[10:11], v[26:27], v[74:75] op_sel_hi:[1,0,1]
    v_pk_fma_f32 v[98:99], v[22:23], v[26:27], v[98:99] op_sel_hi:[1,0,1]
    v_pk_mul_f32 v[32:33], v[68:69], v[240:241] op_sel_hi:[1,0]
    v_pk_mul_f32 v[34:35], v[70:71], v[240:241] op_sel_hi:[1,0]
    v_pk_mul_f32 v[36:37], v[72:73], v[242:243] op_sel_hi:[1,0]
    v_pk_mul_f32 v[38:39], v[74:75], v[242:243] op_sel_hi:[1,0]
    v_pk_fma_f32 v[32:33], v[92:93], v[244:245], v[32:33] op_sel_hi:[1,0,1]
    v_pk_fma_f32 v[34:35], v[94:95], v[244:245], v[34:35] op_sel_hi:[1,0,1]
    v_pk_fma_f32 v[36:37], v[96:97], v[246:247], v[36:37] op_sel_hi:[1,0,1]
    v_pk_fma_f32 v[38:39], v[98:99], v[246:247], v[38:39] op_sel_hi:[1,0,1]
    v_exp_f32 v32, v32
    v_exp_f32 v33, v33
    v_exp_f32 v34, v34
    v_exp_f32 v35, v35
    buffer_load_dwordx4 v[212:215], v2, s[20:23], s59 offen offset:1024 sc1
    v_exp_f32 v36, v36
    v_exp_f32 v37, v37
    v_exp_f32 v38, v38
    v_exp_f32 v39, v39
    s_mov_b32 exec_lo, 0xffff
    s_mov_b32 exec_hi, 0xffff
    buffer_load_dwordx4 v[168:171], v3, s[20:23], s61 offen offset:1024 sc1
    buffer_load_dwordx4 v[172:175], v3, s[20:23], s61 offen offset:1536 sc1
    s_mov_b64 exec, -1
    v_pk_mul_f32 v[68:69], v[68:69], v[92:93]
    v_pk_mul_f32 v[70:71], v[70:71], v[94:95]
    v_pk_mul_f32 v[72:73], v[72:73], v[96:97]
    v_pk_mul_f32 v[74:75], v[74:75], v[98:99]
    v_pk_fma_f32 v[32:33], v[32:33], v[4:5], v[4:5] op_sel_hi:[1,0,0]
    v_pk_fma_f32 v[34:35], v[34:35], v[4:5], v[4:5] op_sel_hi:[1,0,0]
    v_pk_fma_f32 v[36:37], v[36:37], v[6:7], v[6:7] op_sel_hi:[1,0,0]
    v_pk_fma_f32 v[38:39], v[38:39], v[6:7], v[6:7] op_sel_hi:[1,0,0]
    buffer_load_dwordx4 v[216:219], v2, s[20:23], s59 offen offset:2048 sc1
    v_rcp_f32 v32, v32
    v_rcp_f32 v33, v33
    v_rcp_f32 v34, v34
    v_rcp_f32 v35, v35
    s_mov_b32 exec_lo, 0xffff
    s_mov_b32 exec_hi, 0xffff
    buffer_load_dwordx4 v[176:179], v3, s[20:23], s61 offen offset:2048 sc1
    buffer_load_dwordx4 v[180:183], v3, s[20:23], s61 offen offset:2560 sc1
    s_mov_b64 exec, -1
    v_rcp_f32 v36, v36
    v_rcp_f32 v37, v37
    v_rcp_f32 v38, v38
    v_rcp_f32 v39, v39
    buffer_load_dwordx4 v[220:223], v2, s[20:23], s59 offen offset:3072 sc1
    s_nop 0
    v_pk_mul_f32 v[68:69], v[68:69], v[32:33]
    v_pk_mul_f32 v[70:71], v[70:71], v[34:35]
    v_pk_mul_f32 v[72:73], v[72:73], v[36:37]
    v_pk_mul_f32 v[74:75], v[74:75], v[38:39]
    v_cvt_pk_bf16_f32 v116, v68, v69
    v_cvt_pk_bf16_f32 v117, v70, v71
    v_cvt_pk_bf16_f32 v118, v72, v73
    v_cvt_pk_bf16_f32 v119, v74, v75
    s_nop 1
    v_permlane16_swap_b32 v116, v118
    v_permlane16_swap_b32 v117, v119
    v_pk_fma_f32 v[76:77], v[12:13], v[24:25], v[76:77] op_sel_hi:[1,0,1]
    v_pk_fma_f32 v[100:101], v[232:233], v[24:25], v[100:101] op_sel_hi:[1,0,1]
    v_pk_fma_f32 v[78:79], v[14:15], v[24:25], v[78:79] op_sel_hi:[1,0,1]
    v_pk_fma_f32 v[102:103], v[234:235], v[24:25], v[102:103] op_sel_hi:[1,0,1]
    v_pk_fma_f32 v[80:81], v[12:13], v[26:27], v[80:81] op_sel_hi:[1,0,1]
    v_pk_fma_f32 v[104:105], v[232:233], v[26:27], v[104:105] op_sel_hi:[1,0,1]
    v_pk_fma_f32 v[82:83], v[14:15], v[26:27], v[82:83] op_sel_hi:[1,0,1]
    v_pk_fma_f32 v[106:107], v[234:235], v[26:27], v[106:107] op_sel_hi:[1,0,1]
    v_pk_mul_f32 v[40:41], v[76:77], v[240:241] op_sel_hi:[1,0]
    v_pk_mul_f32 v[42:43], v[78:79], v[240:241] op_sel_hi:[1,0]
    v_pk_mul_f32 v[44:45], v[80:81], v[242:243] op_sel_hi:[1,0]
    v_pk_mul_f32 v[46:47], v[82:83], v[242:243] op_sel_hi:[1,0]
    v_pk_fma_f32 v[40:41], v[100:101], v[244:245], v[40:41] op_sel_hi:[1,0,1]
    v_pk_fma_f32 v[42:43], v[102:103], v[244:245], v[42:43] op_sel_hi:[1,0,1]
    v_pk_fma_f32 v[44:45], v[104:105], v[246:247], v[44:45] op_sel_hi:[1,0,1]
    v_pk_fma_f32 v[46:47], v[106:107], v[246:247], v[46:47] op_sel_hi:[1,0,1]
    v_exp_f32 v40, v40
    v_exp_f32 v41, v41
    v_exp_f32 v42, v42
    v_exp_f32 v43, v43
    s_mov_b32 exec_lo, 0xffff
    s_mov_b32 exec_hi, 0xffff
    buffer_load_dwordx4 v[184:187], v3, s[20:23], s61 offen offset:3072 sc1
    buffer_load_dwordx4 v[188:191], v3, s[20:23], s61 offen offset:3584 sc1
    s_mov_b64 exec, -1
    v_exp_f32 v44, v44
    v_exp_f32 v45, v45
    v_exp_f32 v46, v46
    v_exp_f32 v47, v47
    buffer_load_dwordx4 v[228:231], v2, s[20:23], s65 offen sc1
    v_pk_mul_f32 v[76:77], v[76:77], v[100:101]
    v_pk_mul_f32 v[78:79], v[78:79], v[102:103]
    v_pk_mul_f32 v[80:81], v[80:81], v[104:105]
    v_pk_mul_f32 v[82:83], v[82:83], v[106:107]
    v_pk_fma_f32 v[40:41], v[40:41], v[4:5], v[4:5] op_sel_hi:[1,0,0]
    v_pk_fma_f32 v[42:43], v[42:43], v[4:5], v[4:5] op_sel_hi:[1,0,0]
    v_pk_fma_f32 v[44:45], v[44:45], v[6:7], v[6:7] op_sel_hi:[1,0,0]
    v_pk_fma_f32 v[46:47], v[46:47], v[6:7], v[6:7] op_sel_hi:[1,0,0]
    v_rcp_f32 v40, v40
    v_rcp_f32 v41, v41
    v_rcp_f32 v42, v42
    v_rcp_f32 v43, v43
    v_rcp_f32 v44, v44
    v_rcp_f32 v45, v45
    v_rcp_f32 v46, v46
    v_rcp_f32 v47, v47
    s_nop 0
    v_pk_mul_f32 v[76:77], v[76:77], v[40:41]
    v_pk_mul_f32 v[78:79], v[78:79], v[42:43]
    v_pk_mul_f32 v[80:81], v[80:81], v[44:45]
    v_pk_mul_f32 v[82:83], v[82:83], v[46:47]
    v_cvt_pk_bf16_f32 v120, v76, v77
    v_cvt_pk_bf16_f32 v121, v78, v79
    v_cvt_pk_bf16_f32 v122, v80, v81
    v_cvt_pk_bf16_f32 v123, v82, v83
    s_nop 1
    v_permlane16_swap_b32 v120, v122
    v_permlane16_swap_b32 v121, v123
    v_pk_fma_f32 v[84:85], v[16:17], v[24:25], v[84:85] op_sel_hi:[1,0,1]
    v_pk_fma_f32 v[108:109], v[236:237], v[24:25], v[108:109] op_sel_hi:[1,0,1]
    v_pk_fma_f32 v[86:87], v[18:19], v[24:25], v[86:87] op_sel_hi:[1,0,1]
    v_pk_fma_f32 v[110:111], v[238:239], v[24:25], v[110:111] op_sel_hi:[1,0,1]
    v_pk_mul_f32 v[32:33], v[84:85], v[240:241] op_sel_hi:[1,0]
    v_pk_mul_f32 v[34:35], v[86:87], v[240:241] op_sel_hi:[1,0]
    v_pk_fma_f32 v[32:33], v[108:109], v[244:245], v[32:33] op_sel_hi:[1,0,1]
    v_pk_fma_f32 v[34:35], v[110:111], v[244:245], v[34:35] op_sel_hi:[1,0,1]
    v_exp_f32 v32, v32
    v_exp_f32 v33, v33
    v_exp_f32 v34, v34
    v_exp_f32 v35, v35
    v_pk_mul_f32 v[84:85], v[84:85], v[108:109]
    v_pk_mul_f32 v[86:87], v[86:87], v[110:111]
    v_pk_fma_f32 v[32:33], v[32:33], v[4:5], v[4:5] op_sel_hi:[1,0,0]
    v_pk_fma_f32 v[34:35], v[34:35], v[4:5], v[4:5] op_sel_hi:[1,0,0]
    v_rcp_f32 v32, v32
    v_rcp_f32 v33, v33
    v_rcp_f32 v34, v34
    v_rcp_f32 v35, v35
    s_nop 0
    v_pk_mul_f32 v[84:85], v[84:85], v[32:33]
    v_pk_mul_f32 v[86:87], v[86:87], v[34:35]
    v_cvt_pk_bf16_f32 v124, v84, v85
    v_cvt_pk_bf16_f32 v125, v86, v87
L_am_3:
    v_mov_b32 v4, 0xdddddddd
    s_mul_i32 s48, s36, 2304
    s_add_u32 s48, s48, 126976
    v_add_u32 v5, s48, v2
    v_lshl_add_u32 v6, v1, 2, s48
    s_sub_u32 s48, s36, 2
    s_and_b32 s48, s48, 7
    s_mul_i32 s48, s48, 2304
    s_add_u32 s48, s48, 126976
    v_add_u32 v7, s48, v2
    v_lshl_add_u32 v3, v1, 2, s48
    s_setprio 2
    s_waitcnt vmcnt(18)
    v_mfma_f32_32x32x16_bf16 v[32:47], v[192:195], v[224:227], 0
    v_mov_b32 v64, 0
    v_mov_b32 v65, 0
    v_mov_b32 v66, 0
    v_mov_b32 v67, 0
    v_mov_b32 v68, 0
    v_mov_b32 v69, 0
    v_mov_b32 v70, 0
    v_mov_b32 v71, 0
    v_mov_b32 v72, 0
    v_mov_b32 v80, 0
    v_mov_b32 v81, 0
    v_mov_b32 v82, 0
    v_mov_b32 v83, 0
    v_mov_b32 v84, 0
    v_mov_b32 v85, 0
    v_mov_b32 v86, 0
    v_mov_b32 v87, 0
    v_mov_b32 v88, 0
    v_exp_f32 v32, v32
    v_exp_f32 v33, v33
    v_exp_f32 v34, v34
    v_exp_f32 v35, v35
    v_exp_f32 v36, v36
    s_waitcnt vmcnt(18)
    v_mfma_f32_32x32x16_bf16 v[48:63], v[196:199], v[224:227], 0
    v_exp_f32 v37, v37
    v_exp_f32 v38, v38
    v_exp_f32 v39, v39
    v_exp_f32 v40, v40
    v_exp_f32 v41, v41
    s_waitcnt vmcnt(24)
    v_smfmac_f32_32x32x32_bf16 v[64:79], v[128:131], v[32:39], v4
    v_exp_f32 v42, v42
    v_exp_f32 v43, v43
    v_exp_f32 v44, v44
    v_exp_f32 v45, v45
    v_exp_f32 v46, v46
    v_exp_f32 v47, v47
    v_exp_f32 v48, v48
    v_exp_f32 v49, v49
    s_waitcnt vmcnt(23)
    v_smfmac_f32_32x32x32_bf16 v[64:79], v[132:135], v[40:47], v4
    v_exp_f32 v50, v50
    v_exp_f32 v51, v51
    v_exp_f32 v52, v52
    s_waitcnt vmcnt(18)
    v_mfma_f32_32x32x16_bf16 v[32:47], v[200:203], v[224:227], 0
    v_exp_f32 v53, v53
    v_exp_f32 v54, v54
    v_exp_f32 v55, v55
    v_exp_f32 v56, v56
    v_exp_f32 v57, v57
    s_waitcnt vmcnt(21)
    v_smfmac_f32_32x32x32_bf16 v[64:79], v[136:139], v[48:55], v4
    v_exp_f32 v58, v58
    v_exp_f32 v59, v59
    buffer_store_dwordx4 v[116:119], v30, s[20:23], s88 offen sc1
    v_exp_f32 v60, v60
    v_exp_f32 v61, v61
    v_exp_f32 v62, v62
    v_exp_f32 v63, v63
    v_exp_f32 v32, v32
    v_exp_f32 v33, v33
    s_waitcnt vmcnt(21)
    v_smfmac_f32_32x32x32_bf16 v[64:79], v[140:143], v[56:63], v4
    v_exp_f32 v34, v34
    v_exp_f32 v35, v35
    v_exp_f32 v36, v36
    s_waitcnt vmcnt(16)
    v_mfma_f32_32x32x16_bf16 v[48:63], v[204:207], v[224:227], 0
    v_exp_f32 v37, v37
    v_exp_f32 v38, v38
    v_exp_f32 v39, v39
    v_exp_f32 v40, v40
    v_exp_f32 v41, v41
    s_waitcnt vmcnt(18)
    v_smfmac_f32_32x32x32_bf16 v[64:79], v[144:147], v[32:39], v4
    v_exp_f32 v42, v42
    v_exp_f32 v43, v43
    v_exp_f32 v44, v44
    v_exp_f32 v45, v45
    v_exp_f32 v46, v46
    v_exp_f32 v47, v47
    v_exp_f32 v48, v48
    v_exp_f32 v49, v49
    s_waitcnt vmcnt(17)
    v_smfmac_f32_32x32x32_bf16 v[64:79], v[148:151], v[40:47], v4
    v_exp_f32 v50, v50
    v_exp_f32 v51, v51
    v_exp_f32 v52, v52
    s_waitcnt vmcnt(13)
    v_mfma_f32_32x32x16_bf16 v[32:47], v[208:211], v[224:227], 0
    v_exp_f32 v53, v53
    v_exp_f32 v54, v54
    v_exp_f32 v55, v55
    v_exp_f32 v56, v56
    v_exp_f32 v57, v57
    s_waitcnt vmcnt(15)
    v_smfmac_f32_32x32x32_bf16 v[64:79], v[152:155], v[48:55], v4
    v_exp_f32 v58, v58
    v_exp_f32 v59, v59
    buffer_store_dwordx4 v[120:123], v30, s[20:23], s89 offen sc1
    v_exp_f32 v60, v60
    v_exp_f32 v61, v61
    v_exp_f32 v62, v62
    v_exp_f32 v63, v63
    s_setprio 1
    v_exp_f32 v32, v32
    v_exp_f32 v33, v33
    s_waitcnt vmcnt(15)
    v_smfmac_f32_32x32x32_bf16 v[64:79], v[156:159], v[56:63], v4
    v_exp_f32 v34, v34
    v_exp_f32 v35, v35
    v_exp_f32 v36, v36
    s_waitcnt vmcnt(11)
    v_mfma_f32_32x32x16_bf16 v[48:63], v[212:215], v[224:227], 0
    v_exp_f32 v37, v37
    v_exp_f32 v38, v38
    v_exp_f32 v39, v39
    v_exp_f32 v40, v40
    v_exp_f32 v41, v41
    s_waitcnt vmcnt(13)
    v_smfmac_f32_32x32x32_bf16 v[64:79], v[160:163], v[32:39], v4
    v_exp_f32 v42, v42
    v_exp_f32 v43, v43
    v_exp_f32 v44, v44
    v_exp_f32 v45, v45
    v_exp_f32 v46, v46
    v_exp_f32 v47, v47
    v_exp_f32 v48, v48
    v_exp_f32 v49, v49
    s_waitcnt vmcnt(12)
    v_smfmac_f32_32x32x32_bf16 v[64:79], v[164:167], v[40:47], v4
    v_exp_f32 v50, v50
    v_exp_f32 v51, v51
    v_exp_f32 v52, v52
    s_waitcnt vmcnt(8)
    v_mfma_f32_32x32x16_bf16 v[32:47], v[216:219], v[224:227], 0
    v_exp_f32 v53, v53
    v_exp_f32 v54, v54
    v_exp_f32 v55, v55
    v_exp_f32 v56, v56
    v_exp_f32 v57, v57
    s_waitcnt vmcnt(10)
    v_smfmac_f32_32x32x32_bf16 v[64:79], v[168:171], v[48:55], v4
    v_exp_f32 v58, v58
    v_exp_f32 v59, v59
    s_cmp_lg_u32 s38, 0
    s_cbranch_scc1 L_hs_9
    buffer_store_dwordx4 v[124:127], v30, s[20:23], s90 offen sc1
    s_branch L_hs_10
L_hs_9:
    buffer_store_dwordx2 v[124:125], v31, s[20:23], s90 offen sc1
L_hs_10:
    v_exp_f32 v60, v60
    v_exp_f32 v61, v61
    v_exp_f32 v62, v62
    v_exp_f32 v63, v63
    v_exp_f32 v32, v32
    v_exp_f32 v33, v33
    s_waitcnt vmcnt(10)
    v_smfmac_f32_32x32x32_bf16 v[64:79], v[172:175], v[56:63], v4
    v_exp_f32 v34, v34
    v_exp_f32 v35, v35
    v_exp_f32 v36, v36
    s_waitcnt vmcnt(6)
    v_mfma_f32_32x32x16_bf16 v[48:63], v[220:223], v[224:227], 0
    v_exp_f32 v37, v37
    v_exp_f32 v38, v38
    v_exp_f32 v39, v39
    v_exp_f32 v40, v40
    v_exp_f32 v41, v41
    s_waitcnt vmcnt(8)
    v_smfmac_f32_32x32x32_bf16 v[64:79], v[176:179], v[32:39], v4
    v_exp_f32 v42, v42
    v_exp_f32 v43, v43
    v_lshrrev_b32 v8, 3, v1
    v_bfe_u32 v9, v1, 4, 1
    v_lshlrev_b32 v9, 2, v9
    v_and_b32 v10, 7, v1
    v_xor_b32 v9, v9, v10
    v_lshlrev_b32 v9, 4, v9
    v_lshl_add_u32 v9, v8, 10, v9
    s_mul_i32 s48, s72, 352
    s_lshl_b32 s49, s73, 3
    s_add_u32 s48, s48, s49
    s_lshl_b32 s48, s48, 10
    s_lshl_b32 s49, s63, 7
    s_add_u32 s48, s48, s49
    v_add_u32 v0, s48, v9
    s_mul_i32 s48, s72, 2048
    s_lshr_b32 s48, s48, 9
    s_lshr_b32 s49, s62, 1
    s_lshl_b32 s49, s49, 4
    s_add_u32 s48, s48, s49
    s_add_u32 s48, s48, 57600
    v_add_lshl_u32 v8, v1, s48, 8
    s_add_u32 s48, s36, 1
    s_and_b32 s48, s48, 7
    s_lshr_b32 s48, s48, 2
    s_lshl_b32 s49, s57, 1
    s_add_u32 s48, s48, s49
    s_lshl_b32 s48, s48, 4
    s_lshr_b32 s49, s56, 1
    s_add_u32 s48, s48, s49
    s_add_u32 s48, s48, 57600
    s_lshl_b32 s48, s48, 8
    v_writelane_b32 v8, s48, 4
    v_exp_f32 v44, v44
    v_exp_f32 v45, v45
    v_exp_f32 v46, v46
    v_exp_f32 v47, v47
    v_exp_f32 v48, v48
    v_exp_f32 v49, v49
    s_waitcnt vmcnt(7)
    v_smfmac_f32_32x32x32_bf16 v[64:79], v[180:183], v[40:47], v4
    v_exp_f32 v50, v50
    v_exp_f32 v51, v51
    v_exp_f32 v52, v52
    s_waitcnt vmcnt(3)
    v_mfma_f32_32x32x16_bf16 v[32:47], v[192:195], v[228:231], 0
    v_exp_f32 v53, v53
    v_exp_f32 v54, v54
    v_exp_f32 v55, v55
    v_exp_f32 v56, v56
    v_exp_f32 v57, v57
    s_waitcnt vmcnt(5)
    v_smfmac_f32_32x32x32_bf16 v[64:79], v[184:187], v[48:55], v4
    v_exp_f32 v58, v58
    v_exp_f32 v59, v59
    s_lshl_b32 s50, s42, 2
    s_add_u32 s50, s50, s37
    s_lshl_b32 s50, s50, 4
    s_add_u32 s50, s50, s43
    s_lshl_b32 s50, s50, 1
    s_add_u32 s50, s50, s38
    s_lshl_b32 s50, s50, 10
    s_add_u32 s50, s50, 6291456
    v_mov_b32 v24, -1
    v_mov_b32 v25, -1
    v_mov_b32 v26, -1
    v_mov_b32 v27, -1
    buffer_store_dwordx4 v[24:27], v2, s[20:23], s50 offen sc1
    v_exp_f32 v60, v60
    v_exp_f32 v61, v61
    v_exp_f32 v62, v62
    v_exp_f32 v63, v63
    s_setprio 0
    v_exp_f32 v32, v32
    v_exp_f32 v33, v33
    s_waitcnt vmcnt(5)
    v_smfmac_f32_32x32x32_bf16 v[64:79], v[188:191], v[56:63], v4
    v_exp_f32 v34, v34
    v_exp_f32 v35, v35
    v_exp_f32 v36, v36
    v_mfma_f32_32x32x16_bf16 v[48:63], v[196:199], v[228:231], 0
    v_exp_f32 v37, v37
    v_exp_f32 v38, v38
    buffer_load_dwordx4 v[224:227], v2, s[20:23], s66 offen sc1
    v_exp_f32 v39, v39
    v_exp_f32 v40, v40
    v_exp_f32 v41, v41
    v_smfmac_f32_32x32x32_bf16 v[80:95], v[128:131], v[32:39], v4
    v_exp_f32 v42, v42
    v_exp_f32 v43, v43
    s_and_b32 s48, s41, 7
    s_lshl_b32 s49, s48, 3
    s_add_u32 s49, s49, s36
    s_lshl_b32 s49, s49, 13
    s_lshl_b32 s50, s63, 7
    s_add_u32 s49, s49, s50
    v_and_b32 v10, 7, v1
    v_lshlrev_b32 v11, 10, v10
    buffer_load_dword v12, v11, s[28:31], s49 offen
    s_lshl_b32 s49, s73, 3
    s_add_u32 s48, s48, s49
    s_mul_i32 s48, s48, 7
    s_mul_i32 s49, s72, 352
    s_add_u32 s48, s48, s49
    s_add_u32 s48, s48, 240
    s_lshl_b32 s48, s48, 10
    s_add_u32 s48, s48, s50
    buffer_load_dword v12, v11, s[24:27], s48 offen
    v_exp_f32 v44, v44
    v_exp_f32 v45, v45
    ds_write_b128 v5, v[64:67] offset:0
    v_exp_f32 v46, v46
    v_exp_f32 v47, v47
    v_exp_f32 v48, v48
    v_exp_f32 v49, v49
    v_smfmac_f32_32x32x32_bf16 v[80:95], v[132:135], v[40:47], v4
    v_exp_f32 v50, v50
    v_exp_f32 v51, v51
    v_exp_f32 v52, v52
    v_mfma_f32_32x32x16_bf16 v[32:47], v[200:203], v[228:231], 0
    v_exp_f32 v53, v53
    v_exp_f32 v54, v54
    ds_write_b128 v5, v[68:71] offset:1024
    v_exp_f32 v55, v55
    v_exp_f32 v56, v56
    v_exp_f32 v57, v57
    v_smfmac_f32_32x32x32_bf16 v[80:95], v[136:139], v[48:55], v4
    v_exp_f32 v58, v58
    v_exp_f32 v59, v59
    v_exp_f32 v60, v60
    v_exp_f32 v61, v61
    ds_write_b32 v6, v72 offset:2048
    v_exp_f32 v62, v62
    v_exp_f32 v63, v63
    v_exp_f32 v32, v32
    v_exp_f32 v33, v33
    v_smfmac_f32_32x32x32_bf16 v[80:95], v[140:143], v[56:63], v4
    v_exp_f32 v34, v34
    v_exp_f32 v35, v35
    v_exp_f32 v36, v36
    v_mfma_f32_32x32x16_bf16 v[48:63], v[204:207], v[228:231], 0
    v_exp_f32 v37, v37
    v_exp_f32 v38, v38
    v_exp_f32 v39, v39
    v_exp_f32 v40, v40
    v_exp_f32 v41, v41
    v_smfmac_f32_32x32x32_bf16 v[80:95], v[144:147], v[32:39], v4
    v_exp_f32 v42, v42
    v_exp_f32 v43, v43
    v_exp_f32 v44, v44
    v_exp_f32 v45, v45
    v_exp_f32 v46, v46
    v_exp_f32 v47, v47
    v_exp_f32 v48, v48
    v_exp_f32 v49, v49
    v_smfmac_f32_32x32x32_bf16 v[80:95], v[148:151], v[40:47], v4
    v_exp_f32 v50, v50
    v_exp_f32 v51, v51
    v_exp_f32 v52, v52
    v_mfma_f32_32x32x16_bf16 v[32:47], v[208:211], v[228:231], 0
    v_exp_f32 v53, v53
    v_exp_f32 v54, v54
    v_exp_f32 v55, v55
    v_exp_f32 v56, v56
    v_exp_f32 v57, v57
    v_smfmac_f32_32x32x32_bf16 v[80:95], v[152:155], v[48:55], v4
    v_exp_f32 v58, v58
    v_exp_f32 v59, v59
    v_exp_f32 v60, v60
    v_exp_f32 v61, v61
    v_exp_f32 v62, v62
    v_exp_f32 v63, v63
    v_exp_f32 v32, v32
    v_exp_f32 v33, v33
    v_smfmac_f32_32x32x32_bf16 v[80:95], v[156:159], v[56:63], v4
    v_exp_f32 v34, v34
    v_exp_f32 v35, v35
    v_exp_f32 v36, v36
    v_mfma_f32_32x32x16_bf16 v[48:63], v[212:215], v[228:231], 0
    v_exp_f32 v37, v37
    v_exp_f32 v38, v38
    v_exp_f32 v39, v39
    v_exp_f32 v40, v40
    v_exp_f32 v41, v41
    v_smfmac_f32_32x32x32_bf16 v[80:95], v[160:163], v[32:39], v4
    v_exp_f32 v42, v42
    v_exp_f32 v43, v43
    s_waitcnt lgkmcnt(0)
    s_barrier
    s_setprio 3
    v_exp_f32 v44, v44
    v_exp_f32 v45, v45
    v_exp_f32 v46, v46
    v_exp_f32 v47, v47
    v_exp_f32 v48, v48
    v_exp_f32 v49, v49
    v_smfmac_f32_32x32x32_bf16 v[80:95], v[164:167], v[40:47], v4
    v_exp_f32 v50, v50
    v_exp_f32 v51, v51
    v_exp_f32 v52, v52
    v_mfma_f32_32x32x16_bf16 v[32:47], v[216:219], v[228:231], 0
    v_exp_f32 v53, v53
    v_exp_f32 v54, v54
    ds_read_b128 v[64:67], v7 offset:0
    v_exp_f32 v55, v55
    v_exp_f32 v56, v56
    v_exp_f32 v57, v57
    v_smfmac_f32_32x32x32_bf16 v[80:95], v[168:171], v[48:55], v4
    v_exp_f32 v58, v58
    v_exp_f32 v59, v59
    s_add_u32 m0, s93, 0
    s_mov_b32 s49, 0
    buffer_load_dwordx4 v0, s[24:27], s49 offen  lds
    v_exp_f32 v60, v60
    v_exp_f32 v61, v61
    v_exp_f32 v62, v62
    v_exp_f32 v63, v63
    s_setprio 2
    v_exp_f32 v32, v32
    v_exp_f32 v33, v33
    v_smfmac_f32_32x32x32_bf16 v[80:95], v[172:175], v[56:63], v4
    v_exp_f32 v34, v34
    v_exp_f32 v35, v35
    v_exp_f32 v36, v36
    v_mfma_f32_32x32x16_bf16 v[48:63], v[220:223], v[228:231], 0
    v_exp_f32 v37, v37
    v_exp_f32 v38, v38
    ds_read_b128 v[68:71], v7 offset:1024
    v_exp_f32 v39, v39
    v_exp_f32 v40, v40
    v_exp_f32 v41, v41
    v_smfmac_f32_32x32x32_bf16 v[80:95], v[176:179], v[32:39], v4
    v_exp_f32 v42, v42
    v_exp_f32 v43, v43
    s_add_u32 m0, s93, 8192
    s_mov_b32 s49, 16384
    buffer_load_dwordx4 v0, s[24:27], s49 offen  lds
    v_exp_f32 v44, v44
    v_exp_f32 v45, v45
    v_exp_f32 v46, v46
    v_exp_f32 v47, v47
    v_exp_f32 v48, v48
    v_exp_f32 v49, v49
    v_smfmac_f32_32x32x32_bf16 v[80:95], v[180:183], v[40:47], v4
    v_exp_f32 v50, v50
    v_exp_f32 v51, v51
    v_exp_f32 v52, v52
    s_waitcnt vmcnt(4)
    v_mfma_f32_32x32x16_bf16 v[32:47], v[192:195], v[224:227], 0
    v_exp_f32 v53, v53
    v_exp_f32 v54, v54
    ds_read_b32 v72, v3 offset:2048
    v_exp_f32 v55, v55
    v_exp_f32 v56, v56
    v_exp_f32 v57, v57
    v_smfmac_f32_32x32x32_bf16 v[80:95], v[184:187], v[48:55], v4
    v_exp_f32 v58, v58
    v_exp_f32 v59, v59
    s_add_u32 m0, s93, 16384
    s_mov_b32 s49, 32768
    buffer_load_dwordx4 v0, s[24:27], s49 offen  lds
    v_exp_f32 v60, v60
    v_exp_f32 v61, v61
    v_exp_f32 v62, v62
    v_exp_f32 v63, v63
    s_setprio 1
    v_exp_f32 v32, v32
    v_exp_f32 v33, v33
    v_smfmac_f32_32x32x32_bf16 v[80:95], v[188:191], v[56:63], v4
    v_exp_f32 v34, v34
    v_exp_f32 v35, v35
    v_exp_f32 v36, v36
    v_mfma_f32_32x32x16_bf16 v[48:63], v[196:199], v[224:227], 0
    v_exp_f32 v37, v37
    v_exp_f32 v38, v38
    buffer_load_dwordx4 v[228:231], v2, s[20:23], s67 offen sc1
    v_exp_f32 v39, v39
    v_exp_f32 v40, v40
    v_exp_f32 v41, v41
    s_waitcnt lgkmcnt(0)
    v_smfmac_f32_32x32x32_bf16 v[64:79], v[128:131], v[32:39], v4
    v_exp_f32 v42, v42
    v_exp_f32 v43, v43
    s_add_u32 m0, s93, 24576
    s_mov_b32 s49, 49152
    buffer_load_dwordx4 v0, s[24:27], s49 offen  lds
    v_exp_f32 v44, v44
    v_exp_f32 v45, v45
    ds_write_b128 v5, v[80:83] offset:18432
    v_exp_f32 v46, v46
    v_exp_f32 v47, v47
    v_exp_f32 v48, v48
    v_exp_f32 v49, v49
    v_smfmac_f32_32x32x32_bf16 v[64:79], v[132:135], v[40:47], v4
    v_exp_f32 v50, v50
    v_exp_f32 v51, v51
    v_exp_f32 v52, v52
    v_mfma_f32_32x32x16_bf16 v[32:47], v[200:203], v[224:227], 0
    v_exp_f32 v53, v53
    v_exp_f32 v54, v54
    ds_write_b128 v5, v[84:87] offset:19456
    v_exp_f32 v55, v55
    v_exp_f32 v56, v56
    v_exp_f32 v57, v57
    v_smfmac_f32_32x32x32_bf16 v[64:79], v[136:139], v[48:55], v4
    v_exp_f32 v58, v58
    v_exp_f32 v59, v59
    s_add_u32 m0, s93, 32768
    s_mov_b32 s49, 65536
    buffer_load_dwordx4 v0, s[24:27], s49 offen  lds
    v_exp_f32 v60, v60
    v_exp_f32 v61, v61
    ds_write_b32 v6, v88 offset:20480
    v_exp_f32 v62, v62
    v_exp_f32 v63, v63
    s_setprio 0
    v_exp_f32 v32, v32
    v_exp_f32 v33, v33
    v_smfmac_f32_32x32x32_bf16 v[64:79], v[140:143], v[56:63], v4
    v_exp_f32 v34, v34
    v_exp_f32 v35, v35
    v_exp_f32 v36, v36
    v_mfma_f32_32x32x16_bf16 v[48:63], v[204:207], v[224:227], 0
    v_exp_f32 v37, v37
    v_exp_f32 v38, v38
    v_exp_f32 v39, v39
    v_exp_f32 v40, v40
    v_exp_f32 v41, v41
    v_smfmac_f32_32x32x32_bf16 v[64:79], v[144:147], v[32:39], v4
    v_exp_f32 v42, v42
    v_exp_f32 v43, v43
    v_exp_f32 v44, v44
    v_exp_f32 v45, v45
    v_exp_f32 v46, v46
    v_exp_f32 v47, v47
    v_exp_f32 v48, v48
    v_exp_f32 v49, v49
    v_smfmac_f32_32x32x32_bf16 v[64:79], v[148:151], v[40:47], v4
    v_exp_f32 v50, v50
    v_exp_f32 v51, v51
    v_exp_f32 v52, v52
    v_mfma_f32_32x32x16_bf16 v[32:47], v[208:211], v[224:227], 0
    v_exp_f32 v53, v53
    v_exp_f32 v54, v54
    v_exp_f32 v55, v55
    v_exp_f32 v56, v56
    v_exp_f32 v57, v57
    v_smfmac_f32_32x32x32_bf16 v[64:79], v[152:155], v[48:55], v4
    v_exp_f32 v58, v58
    v_exp_f32 v59, v59
    v_exp_f32 v60, v60
    v_exp_f32 v61, v61
    v_exp_f32 v62, v62
    v_exp_f32 v63, v63
    v_exp_f32 v32, v32
    v_exp_f32 v33, v33
    v_smfmac_f32_32x32x32_bf16 v[64:79], v[156:159], v[56:63], v4
    v_exp_f32 v34, v34
    v_exp_f32 v35, v35
    v_exp_f32 v36, v36
    v_mfma_f32_32x32x16_bf16 v[48:63], v[212:215], v[224:227], 0
    v_exp_f32 v37, v37
    v_exp_f32 v38, v38
    v_exp_f32 v39, v39
    v_exp_f32 v40, v40
    v_exp_f32 v41, v41
    v_smfmac_f32_32x32x32_bf16 v[64:79], v[160:163], v[32:39], v4
    v_exp_f32 v42, v42
    v_exp_f32 v43, v43
    s_waitcnt lgkmcnt(0)
    s_waitcnt vmcnt(9)
    s_barrier
    s_lshl_b32 s48, s42, 4
    s_add_u32 s48, s48, s43
    s_lshl_b32 s48, s48, 8
    s_add_u32 s51, s48, 14745600
    s_cmp_lg_u32 s36, 0
    s_cbranch_scc1 L_sig_11
    v_mov_b32 v17, s3
    s_mov_b32 exec_hi, 0
    v_lshlrev_b32 v20, 2, v1
    buffer_store_dword v17, v20, s[20:23], s51 offen sc1
    s_mov_b64 exec, -1
L_sig_11:
    s_setprio 3
    s_add_u32 m0, s93, 40960
    s_mov_b32 s49, 81920
    buffer_load_dwordx4 v0, s[24:27], s49 offen  lds
    v_exp_f32 v44, v44
    v_exp_f32 v45, v45
    v_exp_f32 v46, v46
    v_exp_f32 v47, v47
    v_exp_f32 v48, v48
    v_exp_f32 v49, v49
    v_smfmac_f32_32x32x32_bf16 v[64:79], v[164:167], v[40:47], v4
    v_exp_f32 v50, v50
    v_exp_f32 v51, v51
    v_exp_f32 v52, v52
    v_mfma_f32_32x32x16_bf16 v[32:47], v[216:219], v[224:227], 0
    v_exp_f32 v53, v53
    v_exp_f32 v54, v54
    ds_read_b128 v[80:83], v7 offset:18432
    v_exp_f32 v55, v55
    v_exp_f32 v56, v56
    v_exp_f32 v57, v57
    v_smfmac_f32_32x32x32_bf16 v[64:79], v[168:171], v[48:55], v4
    v_exp_f32 v58, v58
    v_exp_f32 v59, v59
    s_add_u32 m0, s93, 49152
    s_mov_b32 s49, 98304
    buffer_load_dwordx4 v0, s[24:27], s49 offen  lds
    v_exp_f32 v60, v60
    v_exp_f32 v61, v61
    v_exp_f32 v62, v62
    v_exp_f32 v63, v63
    s_setprio 2
    v_exp_f32 v32, v32
    v_exp_f32 v33, v33
    v_smfmac_f32_32x32x32_bf16 v[64:79], v[172:175], v[56:63], v4
    v_exp_f32 v34, v34
    v_exp_f32 v35, v35
    v_exp_f32 v36, v36
    v_mfma_f32_32x32x16_bf16 v[48:63], v[220:223], v[224:227], 0
    v_exp_f32 v37, v37
    v_exp_f32 v38, v38
    ds_read_b128 v[84:87], v7 offset:19456
    v_exp_f32 v39, v39
    v_exp_f32 v40, v40
    v_exp_f32 v41, v41
    v_smfmac_f32_32x32x32_bf16 v[64:79], v[176:179], v[32:39], v4
    v_exp_f32 v42, v42
    v_exp_f32 v43, v43
    s_add_u32 m0, s93, 57344
    s_mov_b32 s49, 114688
    buffer_load_dwordx4 v0, s[24:27], s49 offen  lds
    v_exp_f32 v44, v44
    v_exp_f32 v45, v45
    v_exp_f32 v46, v46
    v_exp_f32 v47, v47
    v_exp_f32 v48, v48
    v_exp_f32 v49, v49
    v_smfmac_f32_32x32x32_bf16 v[64:79], v[180:183], v[40:47], v4
    v_exp_f32 v50, v50
    v_exp_f32 v51, v51
    v_exp_f32 v52, v52
    s_waitcnt vmcnt(5)
    v_mfma_f32_32x32x16_bf16 v[32:47], v[192:195], v[228:231], 0
    v_exp_f32 v53, v53
    v_exp_f32 v54, v54
    ds_read_b32 v88, v3 offset:20480
    v_exp_f32 v55, v55
    v_exp_f32 v56, v56
    v_exp_f32 v57, v57
    v_smfmac_f32_32x32x32_bf16 v[64:79], v[184:187], v[48:55], v4
    v_exp_f32 v58, v58
    v_exp_f32 v59, v59
    s_add_u32 m0, s93, 65536
    s_mov_b32 s49, 131072
    buffer_load_dwordx4 v0, s[24:27], s49 offen  lds
    v_exp_f32 v60, v60
    v_exp_f32 v61, v61
    v_exp_f32 v62, v62
    v_exp_f32 v63, v63
    s_setprio 1
    v_exp_f32 v32, v32
    v_exp_f32 v33, v33
    v_smfmac_f32_32x32x32_bf16 v[64:79], v[188:191], v[56:63], v4
    v_exp_f32 v34, v34
    v_exp_f32 v35, v35
    v_exp_f32 v36, v36
    v_mfma_f32_32x32x16_bf16 v[48:63], v[196:199], v[228:231], 0
    v_exp_f32 v37, v37
    v_exp_f32 v38, v38
    buffer_load_dwordx4 v[224:227], v2, s[20:23], s68 offen sc1
    v_exp_f32 v39, v39
    v_exp_f32 v40, v40
    v_exp_f32 v41, v41
    s_waitcnt lgkmcnt(0)
    v_smfmac_f32_32x32x32_bf16 v[80:95], v[128:131], v[32:39], v4
    v_exp_f32 v42, v42
    v_exp_f32 v43, v43
    s_add_u32 m0, s93, 73728
    s_mov_b32 s49, 147456
    buffer_load_dwordx4 v0, s[24:27], s49 offen  lds
    v_exp_f32 v44, v44
    v_exp_f32 v45, v45
    ds_write_b128 v5, v[64:67] offset:0
    v_exp_f32 v46, v46
    v_exp_f32 v47, v47
    v_exp_f32 v48, v48
    v_exp_f32 v49, v49
    v_smfmac_f32_32x32x32_bf16 v[80:95], v[132:135], v[40:47], v4
    v_exp_f32 v50, v50
    v_exp_f32 v51, v51
    v_exp_f32 v52, v52
    v_mfma_f32_32x32x16_bf16 v[32:47], v[200:203], v[228:231], 0
    v_exp_f32 v53, v53
    v_exp_f32 v54, v54
    ds_write_b128 v5, v[68:71] offset:1024
    v_exp_f32 v55, v55
    v_exp_f32 v56, v56
    v_exp_f32 v57, v57
    v_smfmac_f32_32x32x32_bf16 v[80:95], v[136:139], v[48:55], v4
    v_exp_f32 v58, v58
    v_exp_f32 v59, v59
    s_add_u32 m0, s93, 81920
    s_mov_b32 s49, 163840
    buffer_load_dwordx4 v0, s[24:27], s49 offen  lds
    v_exp_f32 v60, v60
    v_exp_f32 v61, v61
    ds_write_b32 v6, v72 offset:2048
    v_exp_f32 v62, v62
    v_exp_f32 v63, v63
    s_setprio 0
    v_exp_f32 v32, v32
    v_exp_f32 v33, v33
    v_smfmac_f32_32x32x32_bf16 v[80:95], v[140:143], v[56:63], v4
    v_exp_f32 v34, v34
    v_exp_f32 v35, v35
    v_exp_f32 v36, v36
    v_mfma_f32_32x32x16_bf16 v[48:63], v[204:207], v[228:231], 0
    v_exp_f32 v37, v37
    v_exp_f32 v38, v38
    v_exp_f32 v39, v39
    v_exp_f32 v40, v40
    v_exp_f32 v41, v41
    v_smfmac_f32_32x32x32_bf16 v[80:95], v[144:147], v[32:39], v4
    v_exp_f32 v42, v42
    v_exp_f32 v43, v43
    v_exp_f32 v44, v44
    v_exp_f32 v45, v45
    v_exp_f32 v46, v46
    v_exp_f32 v47, v47
    v_exp_f32 v48, v48
    v_exp_f32 v49, v49
    v_smfmac_f32_32x32x32_bf16 v[80:95], v[148:151], v[40:47], v4
    v_exp_f32 v50, v50
    v_exp_f32 v51, v51
    v_exp_f32 v52, v52
    v_mfma_f32_32x32x16_bf16 v[32:47], v[208:211], v[228:231], 0
    v_exp_f32 v53, v53
    v_exp_f32 v54, v54
    v_exp_f32 v55, v55
    v_exp_f32 v56, v56
    v_exp_f32 v57, v57
    v_smfmac_f32_32x32x32_bf16 v[80:95], v[152:155], v[48:55], v4
    v_exp_f32 v58, v58
    v_exp_f32 v59, v59
    v_exp_f32 v60, v60
    v_exp_f32 v61, v61
    v_exp_f32 v62, v62
    v_exp_f32 v63, v63
    v_exp_f32 v32, v32
    v_exp_f32 v33, v33
    v_smfmac_f32_32x32x32_bf16 v[80:95], v[156:159], v[56:63], v4
    v_exp_f32 v34, v34
    v_exp_f32 v35, v35
    v_exp_f32 v36, v36
    v_mfma_f32_32x32x16_bf16 v[48:63], v[212:215], v[228:231], 0
    v_exp_f32 v37, v37
    v_exp_f32 v38, v38
    v_exp_f32 v39, v39
    v_exp_f32 v40, v40
    v_exp_f32 v41, v41
    v_smfmac_f32_32x32x32_bf16 v[80:95], v[160:163], v[32:39], v4
    v_exp_f32 v42, v42
    v_exp_f32 v43, v43
    s_waitcnt lgkmcnt(0)
    s_barrier
    s_setprio 3
    s_add_u32 m0, s93, 90112
    s_mov_b32 s49, 180224
    buffer_load_dwordx4 v0, s[24:27], s49 offen  lds
    v_exp_f32 v44, v44
    v_exp_f32 v45, v45
    v_exp_f32 v46, v46
    v_exp_f32 v47, v47
    v_exp_f32 v48, v48
    v_exp_f32 v49, v49
    v_smfmac_f32_32x32x32_bf16 v[80:95], v[164:167], v[40:47], v4
    v_exp_f32 v50, v50
    v_exp_f32 v51, v51
    v_exp_f32 v52, v52
    v_mfma_f32_32x32x16_bf16 v[32:47], v[216:219], v[228:231], 0
    v_exp_f32 v53, v53
    v_exp_f32 v54, v54
    ds_read_b128 v[64:67], v7 offset:0
    v_exp_f32 v55, v55
    v_exp_f32 v56, v56
    v_exp_f32 v57, v57
    v_smfmac_f32_32x32x32_bf16 v[80:95], v[168:171], v[48:55], v4
    v_exp_f32 v58, v58
    v_exp_f32 v59, v59
    s_add_u32 m0, s93, 98304
    s_mov_b32 s49, 196608
    buffer_load_dwordx4 v0, s[24:27], s49 offen  lds
    v_exp_f32 v60, v60
    v_exp_f32 v61, v61
    v_exp_f32 v62, v62
    v_exp_f32 v63, v63
    s_setprio 2
    v_exp_f32 v32, v32
    v_exp_f32 v33, v33
    v_smfmac_f32_32x32x32_bf16 v[80:95], v[172:175], v[56:63], v4
    v_exp_f32 v34, v34
    v_exp_f32 v35, v35
    v_exp_f32 v36, v36
    v_mfma_f32_32x32x16_bf16 v[48:63], v[220:223], v[228:231], 0
    v_exp_f32 v37, v37
    v_exp_f32 v38, v38
    ds_read_b128 v[68:71], v7 offset:1024
    v_exp_f32 v39, v39
    v_exp_f32 v40, v40
    v_exp_f32 v41, v41
    v_smfmac_f32_32x32x32_bf16 v[80:95], v[176:179], v[32:39], v4
    v_exp_f32 v42, v42
    v_exp_f32 v43, v43
    s_add_u32 m0, s93, 106496
    s_mov_b32 s49, 212992
    buffer_load_dwordx4 v0, s[24:27], s49 offen  lds
    s_getpc_b64 s[4:5]
L_pc_12:
    v_min_u32 v252, 3, v1
    v_lshl_add_u32 v252, s41, 2, v252
    v_lshlrev_b32 v252, 7, v252
    v_min_u32 v252, L_end-L_pc_12-4, v252
    global_load_dword v253, v252, s[4:5]
    v_exp_f32 v44, v44
    v_exp_f32 v45, v45
    v_exp_f32 v46, v46
    v_exp_f32 v47, v47
    v_exp_f32 v48, v48
    v_exp_f32 v49, v49
    v_smfmac_f32_32x32x32_bf16 v[80:95], v[180:183], v[40:47], v4
    v_exp_f32 v50, v50
    v_exp_f32 v51, v51
    v_exp_f32 v52, v52
    s_waitcnt vmcnt(6)
    v_mfma_f32_32x32x16_bf16 v[32:47], v[192:195], v[224:227], 0
    v_exp_f32 v53, v53
    v_exp_f32 v54, v54
    ds_read_b32 v72, v3 offset:2048
    v_exp_f32 v55, v55
    v_exp_f32 v56, v56
    v_exp_f32 v57, v57
    v_smfmac_f32_32x32x32_bf16 v[80:95], v[184:187], v[48:55], v4
    v_exp_f32 v58, v58
    v_exp_f32 v59, v59
    s_add_u32 m0, s93, 114688
    s_mov_b32 s49, 229376
    buffer_load_dwordx4 v0, s[24:27], s49 offen  lds
    v_exp_f32 v60, v60
    v_exp_f32 v61, v61
    v_exp_f32 v62, v62
    v_exp_f32 v63, v63
    s_setprio 1
    v_exp_f32 v32, v32
    v_exp_f32 v33, v33
    v_smfmac_f32_32x32x32_bf16 v[80:95], v[188:191], v[56:63], v4
    v_exp_f32 v34, v34
    v_exp_f32 v35, v35
    v_exp_f32 v36, v36
    v_mfma_f32_32x32x16_bf16 v[48:63], v[196:199], v[224:227], 0
    v_exp_f32 v37, v37
    v_exp_f32 v38, v38
    buffer_load_dwordx4 v[228:231], v2, s[20:23], s69 offen sc1
    v_exp_f32 v39, v39
    v_exp_f32 v40, v40
    v_exp_f32 v41, v41
    s_waitcnt lgkmcnt(0)
    v_smfmac_f32_32x32x32_bf16 v[64:79], v[128:131], v[32:39], v4
    v_exp_f32 v42, v42
    v_exp_f32 v43, v43
    s_mov_b64 exec, 0x1f
    buffer_load_dword v9, v8, s[20:23], 0 offen sc1
    s_mov_b64 exec, -1
    v_exp_f32 v44, v44
    v_exp_f32 v45, v45
    ds_write_b128 v5, v[80:83] offset:18432
    v_exp_f32 v46, v46
    v_exp_f32 v47, v47
    v_exp_f32 v48, v48
    v_exp_f32 v49, v49
    v_smfmac_f32_32x32x32_bf16 v[64:79], v[132:135], v[40:47], v4
    v_exp_f32 v50, v50
    v_exp_f32 v51, v51
    v_exp_f32 v52, v52
    v_mfma_f32_32x32x16_bf16 v[32:47], v[200:203], v[224:227], 0
    v_exp_f32 v53, v53
    v_exp_f32 v54, v54
    ds_write_b128 v5, v[84:87] offset:19456
    v_exp_f32 v55, v55
    v_exp_f32 v56, v56
    v_exp_f32 v57, v57
    v_smfmac_f32_32x32x32_bf16 v[64:79], v[136:139], v[48:55], v4
    v_exp_f32 v58, v58
    v_exp_f32 v59, v59
    v_exp_f32 v60, v60
    v_exp_f32 v61, v61
    ds_write_b32 v6, v88 offset:20480
    v_exp_f32 v62, v62
    v_exp_f32 v63, v63
    s_setprio 0
    v_exp_f32 v32, v32
    v_exp_f32 v33, v33
    v_smfmac_f32_32x32x32_bf16 v[64:79], v[140:143], v[56:63], v4
    v_exp_f32 v34, v34
    v_exp_f32 v35, v35
    v_exp_f32 v36, v36
    v_mfma_f32_32x32x16_bf16 v[48:63], v[204:207], v[224:227], 0
    v_exp_f32 v37, v37
    v_exp_f32 v38, v38
    v_exp_f32 v39, v39
    v_exp_f32 v40, v40
    v_exp_f32 v41, v41
    v_smfmac_f32_32x32x32_bf16 v[64:79], v[144:147], v[32:39], v4
    v_exp_f32 v42, v42
    v_exp_f32 v43, v43
    v_exp_f32 v44, v44
    v_exp_f32 v45, v45
    v_exp_f32 v46, v46
    v_exp_f32 v47, v47
    v_exp_f32 v48, v48
    v_exp_f32 v49, v49
    v_smfmac_f32_32x32x32_bf16 v[64:79], v[148:151], v[40:47], v4
    v_exp_f32 v50, v50
    v_exp_f32 v51, v51
    v_exp_f32 v52, v52
    v_mfma_f32_32x32x16_bf16 v[32:47], v[208:211], v[224:227], 0
    v_exp_f32 v53, v53
    v_exp_f32 v54, v54
    v_exp_f32 v55, v55
    v_exp_f32 v56, v56
    v_exp_f32 v57, v57
    v_smfmac_f32_32x32x32_bf16 v[64:79], v[152:155], v[48:55], v4
    v_exp_f32 v58, v58
    v_exp_f32 v59, v59
    v_exp_f32 v60, v60
    v_exp_f32 v61, v61
    v_exp_f32 v62, v62
    v_exp_f32 v63, v63
    v_exp_f32 v32, v32
    v_exp_f32 v33, v33
    v_smfmac_f32_32x32x32_bf16 v[64:79], v[156:159], v[56:63], v4
    v_exp_f32 v34, v34
    v_exp_f32 v35, v35
    v_exp_f32 v36, v36
    v_mfma_f32_32x32x16_bf16 v[48:63], v[212:215], v[224:227], 0
    v_exp_f32 v37, v37
    v_exp_f32 v38, v38
    v_exp_f32 v39, v39
    v_exp_f32 v40, v40
    v_exp_f32 v41, v41
    v_smfmac_f32_32x32x32_bf16 v[64:79], v[160:163], v[32:39], v4
    v_exp_f32 v42, v42
    v_exp_f32 v43, v43
    s_waitcnt lgkmcnt(0)
    s_barrier
    s_setprio 3
    v_exp_f32 v44, v44
    v_exp_f32 v45, v45
    v_exp_f32 v46, v46
    v_exp_f32 v47, v47
    v_exp_f32 v48, v48
    v_exp_f32 v49, v49
    v_smfmac_f32_32x32x32_bf16 v[64:79], v[164:167], v[40:47], v4
    v_exp_f32 v50, v50
    v_exp_f32 v51, v51
    v_exp_f32 v52, v52
    v_mfma_f32_32x32x16_bf16 v[32:47], v[216:219], v[224:227], 0
    v_exp_f32 v53, v53
    v_exp_f32 v54, v54
    ds_read_b128 v[80:83], v7 offset:18432
    v_exp_f32 v55, v55
    v_exp_f32 v56, v56
    v_exp_f32 v57, v57
    v_smfmac_f32_32x32x32_bf16 v[64:79], v[168:171], v[48:55], v4
    v_exp_f32 v58, v58
    v_exp_f32 v59, v59
    s_waitcnt vmcnt(0)
    s_mov_b64 exec, 0x1f
    v_cmp_ne_u32 vcc, s3, v9
    s_mov_b32 s79, 20000
    s_cbranch_vccz L_pok_13
L_psp_14:
    s_sleep 8
    buffer_load_dword v9, v8, s[20:23], 0 offen sc1
    s_sub_u32 s79, s79, 1
    s_waitcnt vmcnt(0)
    v_cmp_ne_u32 vcc, s3, v9
    s_cmp_eq_u32 s79, 0
    s_cbranch_scc1 L_pok_13
    s_cbranch_vccnz L_psp_14
L_pok_13:
    s_mov_b64 exec, -1
    v_exp_f32 v60, v60
    v_exp_f32 v61, v61
    v_exp_f32 v62, v62
    v_exp_f32 v63, v63
    s_setprio 2
    v_exp_f32 v32, v32
    v_exp_f32 v33, v33
    v_smfmac_f32_32x32x32_bf16 v[64:79], v[172:175], v[56:63], v4
    v_exp_f32 v34, v34
    v_exp_f32 v35, v35
    v_exp_f32 v36, v36
    v_mfma_f32_32x32x16_bf16 v[48:63], v[220:223], v[224:227], 0
    v_exp_f32 v37, v37
    v_exp_f32 v38, v38
    ds_read_b128 v[84:87], v7 offset:19456
    v_exp_f32 v39, v39
    v_exp_f32 v40, v40
    v_exp_f32 v41, v41
    v_smfmac_f32_32x32x32_bf16 v[64:79], v[176:179], v[32:39], v4
    v_exp_f32 v42, v42
    v_exp_f32 v43, v43
    s_add_u32 s78, s74, 0
    buffer_load_dwordx4 v[8:11], v2, s[20:23], s78 offen offset:0 sc1
    v_exp_f32 v44, v44
    v_exp_f32 v45, v45
    v_exp_f32 v46, v46
    v_exp_f32 v47, v47
    v_exp_f32 v48, v48
    v_exp_f32 v49, v49
    v_smfmac_f32_32x32x32_bf16 v[64:79], v[180:183], v[40:47], v4
    v_exp_f32 v50, v50
    v_exp_f32 v51, v51
    v_exp_f32 v52, v52
    s_waitcnt vmcnt(2)
    v_mfma_f32_32x32x16_bf16 v[32:47], v[192:195], v[228:231], 0
    v_exp_f32 v53, v53
    v_exp_f32 v54, v54
    ds_read_b32 v88, v3 offset:20480
    v_exp_f32 v55, v55
    v_exp_f32 v56, v56
    v_exp_f32 v57, v57
    v_smfmac_f32_32x32x32_bf16 v[64:79], v[184:187], v[48:55], v4
    v_exp_f32 v58, v58
    v_exp_f32 v59, v59
    buffer_load_dwordx4 v[12:15], v2, s[20:23], s78 offen offset:1024 sc1
    v_exp_f32 v60, v60
    v_exp_f32 v61, v61
    v_exp_f32 v62, v62
    v_exp_f32 v63, v63
    s_setprio 1
    v_exp_f32 v32, v32
    v_exp_f32 v33, v33
    v_smfmac_f32_32x32x32_bf16 v[64:79], v[188:191], v[56:63], v4
    v_exp_f32 v34, v34
    v_exp_f32 v35, v35
    v_exp_f32 v36, v36
    v_mfma_f32_32x32x16_bf16 v[48:63], v[196:199], v[228:231], 0
    v_exp_f32 v37, v37
    v_exp_f32 v38, v38
    buffer_load_dwordx4 v[224:227], v2, s[20:23], s70 offen sc1
    v_exp_f32 v39, v39
    v_exp_f32 v40, v40
    v_exp_f32 v41, v41
    s_waitcnt lgkmcnt(0)
    v_smfmac_f32_32x32x32_bf16 v[80:95], v[128:131], v[32:39], v4
    v_exp_f32 v42, v42
    v_exp_f32 v43, v43
    buffer_load_dwordx4 v[16:19], v2, s[20:23], s78 offen offset:2048 sc1
    v_exp_f32 v44, v44
    v_exp_f32 v45, v45
    ds_write_b128 v5, v[64:67] offset:0
    v_exp_f32 v46, v46
    v_exp_f32 v47, v47
    v_exp_f32 v48, v48
    v_exp_f32 v49, v49
    v_smfmac_f32_32x32x32_bf16 v[80:95], v[132:135], v[40:47], v4
    v_exp_f32 v50, v50
    v_exp_f32 v51, v51
    v_exp_f32 v52, v52
    v_mfma_f32_32x32x16_bf16 v[32:47], v[200:203], v[228:231], 0
    v_exp_f32 v53, v53
    v_exp_f32 v54, v54
    ds_write_b128 v5, v[68:71] offset:1024
    v_exp_f32 v55, v55
    v_exp_f32 v56, v56
    v_exp_f32 v57, v57
    v_smfmac_f32_32x32x32_bf16 v[80:95], v[136:139], v[48:55], v4
    v_exp_f32 v58, v58
    v_exp_f32 v59, v59
    buffer_load_dwordx4 v[20:23], v2, s[20:23], s78 offen offset:3072 sc1
    v_exp_f32 v60, v60
    v_exp_f32 v61, v61
    ds_write_b32 v6, v72 offset:2048
    v_exp_f32 v62, v62
    v_exp_f32 v63, v63
    s_setprio 0
    v_exp_f32 v32, v32
    v_exp_f32 v33, v33
    v_smfmac_f32_32x32x32_bf16 v[80:95], v[140:143], v[56:63], v4
    v_exp_f32 v34, v34
    v_exp_f32 v35, v35
    v_exp_f32 v36, v36
    v_mfma_f32_32x32x16_bf16 v[48:63], v[204:207], v[228:231], 0
    v_exp_f32 v37, v37
    v_exp_f32 v38, v38
    v_exp_f32 v39, v39
    v_exp_f32 v40, v40
    v_exp_f32 v41, v41
    v_smfmac_f32_32x32x32_bf16 v[80:95], v[144:147], v[32:39], v4
    v_exp_f32 v42, v42
    v_exp_f32 v43, v43
    v_exp_f32 v44, v44
    v_exp_f32 v45, v45
    v_exp_f32 v46, v46
    v_exp_f32 v47, v47
    v_exp_f32 v48, v48
    v_exp_f32 v49, v49
    v_smfmac_f32_32x32x32_bf16 v[80:95], v[148:151], v[40:47], v4
    v_exp_f32 v50, v50
    v_exp_f32 v51, v51
    v_exp_f32 v52, v52
    v_mfma_f32_32x32x16_bf16 v[32:47], v[208:211], v[228:231], 0
    v_exp_f32 v53, v53
    v_exp_f32 v54, v54
    v_exp_f32 v55, v55
    v_exp_f32 v56, v56
    v_exp_f32 v57, v57
    v_smfmac_f32_32x32x32_bf16 v[80:95], v[152:155], v[48:55], v4
    v_exp_f32 v58, v58
    v_exp_f32 v59, v59
    v_exp_f32 v60, v60
    v_exp_f32 v61, v61
    v_exp_f32 v62, v62
    v_exp_f32 v63, v63
    v_exp_f32 v32, v32
    v_exp_f32 v33, v33
    v_smfmac_f32_32x32x32_bf16 v[80:95], v[156:159], v[56:63], v4
    v_exp_f32 v34, v34
    v_exp_f32 v35, v35
    v_exp_f32 v36, v36
    v_mfma_f32_32x32x16_bf16 v[48:63], v[212:215], v[228:231], 0
    v_exp_f32 v37, v37
    v_exp_f32 v38, v38
    v_exp_f32 v39, v39
    v_exp_f32 v40, v40
    v_exp_f32 v41, v41
    v_smfmac_f32_32x32x32_bf16 v[80:95], v[160:163], v[32:39], v4
    v_exp_f32 v42, v42
    v_exp_f32 v43, v43
    s_waitcnt lgkmcnt(0)
    s_barrier
    s_setprio 3
    s_add_u32 s78, s74, 4096
    buffer_load_dwordx4 v[24:27], v2, s[20:23], s78 offen offset:0 sc1
    v_exp_f32 v44, v44
    v_exp_f32 v45, v45
    v_exp_f32 v46, v46
    v_exp_f32 v47, v47
    v_exp_f32 v48, v48
    v_exp_f32 v49, v49
    v_smfmac_f32_32x32x32_bf16 v[80:95], v[164:167], v[40:47], v4
    v_exp_f32 v50, v50
    v_exp_f32 v51, v51
    v_exp_f32 v52, v52
    v_mfma_f32_32x32x16_bf16 v[32:47], v[216:219], v[228:231], 0
    v_exp_f32 v53, v53
    v_exp_f32 v54, v54
    ds_read_b128 v[64:67], v7 offset:0
    v_exp_f32 v55, v55
    v_exp_f32 v56, v56
    v_exp_f32 v57, v57
    v_smfmac_f32_32x32x32_bf16 v[80:95], v[168:171], v[48:55], v4
    v_exp_f32 v58, v58
    v_exp_f32 v59, v59
    buffer_load_dwordx4 v[28:31], v2, s[20:23], s78 offen offset:1024 sc1
    v_exp_f32 v60, v60
    v_exp_f32 v61, v61
    v_exp_f32 v62, v62
    v_exp_f32 v63, v63
    s_setprio 2
    v_exp_f32 v32, v32
    v_exp_f32 v33, v33
    v_smfmac_f32_32x32x32_bf16 v[80:95], v[172:175], v[56:63], v4
    v_exp_f32 v34, v34
    v_exp_f32 v35, v35
    v_exp_f32 v36, v36
    v_mfma_f32_32x32x16_bf16 v[48:63], v[220:223], v[228:231], 0
    v_exp_f32 v37, v37
    v_exp_f32 v38, v38
    ds_read_b128 v[68:71], v7 offset:1024
    v_exp_f32 v39, v39
    v_exp_f32 v40, v40
    v_exp_f32 v41, v41
    v_smfmac_f32_32x32x32_bf16 v[80:95], v[176:179], v[32:39], v4
    v_exp_f32 v42, v42
    v_exp_f32 v43, v43
    buffer_load_dwordx4 v[96:99], v2, s[20:23], s78 offen offset:2048 sc1
    v_exp_f32 v44, v44
    v_exp_f32 v45, v45
    v_exp_f32 v46, v46
    v_exp_f32 v47, v47
    v_exp_f32 v48, v48
    v_exp_f32 v49, v49
    v_smfmac_f32_32x32x32_bf16 v[80:95], v[180:183], v[40:47], v4
    v_exp_f32 v50, v50
    v_exp_f32 v51, v51
    v_exp_f32 v52, v52
    s_waitcnt vmcnt(5)
    v_mfma_f32_32x32x16_bf16 v[32:47], v[192:195], v[224:227], 0
    v_exp_f32 v53, v53
    v_exp_f32 v54, v54
    ds_read_b32 v72, v3 offset:2048
    v_exp_f32 v55, v55
    v_exp_f32 v56, v56
    v_exp_f32 v57, v57
    v_smfmac_f32_32x32x32_bf16 v[80:95], v[184:187], v[48:55], v4
    v_exp_f32 v58, v58
    v_exp_f32 v59, v59
    buffer_load_dwordx4 v[100:103], v2, s[20:23], s78 offen offset:3072 sc1
    v_exp_f32 v60, v60
    v_exp_f32 v61, v61
    v_exp_f32 v62, v62
    v_exp_f32 v63, v63
    s_setprio 1
    v_exp_f32 v32, v32
    v_exp_f32 v33, v33
    v_smfmac_f32_32x32x32_bf16 v[80:95], v[188:191], v[56:63], v4
    v_exp_f32 v34, v34
    v_exp_f32 v35, v35
    v_exp_f32 v36, v36
    v_mfma_f32_32x32x16_bf16 v[48:63], v[196:199], v[224:227], 0
    v_exp_f32 v37, v37
    v_exp_f32 v38, v38
    buffer_load_dwordx4 v[228:231], v2, s[20:23], s71 offen sc1
    v_exp_f32 v39, v39
    v_exp_f32 v40, v40
    v_exp_f32 v41, v41
    s_waitcnt lgkmcnt(0)
    v_smfmac_f32_32x32x32_bf16 v[64:79], v[128:131], v[32:39], v4
    v_exp_f32 v42, v42
    v_exp_f32 v43, v43
    s_add_u32 s78, s74, 8192
    buffer_load_dwordx4 v[104:107], v2, s[20:23], s78 offen offset:0 sc1
    v_exp_f32 v44, v44
    v_exp_f32 v45, v45
    ds_write_b128 v5, v[80:83] offset:18432
    v_exp_f32 v46, v46
    v_exp_f32 v47, v47
    v_exp_f32 v48, v48
    v_exp_f32 v49, v49
    v_smfmac_f32_32x32x32_bf16 v[64:79], v[132:135], v[40:47], v4
    v_exp_f32 v50, v50
    v_exp_f32 v51, v51
    v_exp_f32 v52, v52
    v_mfma_f32_32x32x16_bf16 v[32:47], v[200:203], v[224:227], 0
    v_exp_f32 v53, v53
    v_exp_f32 v54, v54
    ds_write_b128 v5, v[84:87] offset:19456
    v_exp_f32 v55, v55
    v_exp_f32 v56, v56
    v_exp_f32 v57, v57
    v_smfmac_f32_32x32x32_bf16 v[64:79], v[136:139], v[48:55], v4
    v_exp_f32 v58, v58
    v_exp_f32 v59, v59
    buffer_load_dwordx4 v[108:111], v2, s[20:23], s78 offen offset:1024 sc1
    v_exp_f32 v60, v60
    v_exp_f32 v61, v61
    ds_write_b32 v6, v88 offset:20480
    v_exp_f32 v62, v62
    v_exp_f32 v63, v63
    s_setprio 0
    v_exp_f32 v32, v32
    v_exp_f32 v33, v33
    v_smfmac_f32_32x32x32_bf16 v[64:79], v[140:143], v[56:63], v4
    v_exp_f32 v34, v34
    v_exp_f32 v35, v35
    v_exp_f32 v36, v36
    v_mfma_f32_32x32x16_bf16 v[48:63], v[204:207], v[224:227], 0
    v_exp_f32 v37, v37
    v_exp_f32 v38, v38
    v_exp_f32 v39, v39
    v_exp_f32 v40, v40
    v_exp_f32 v41, v41
    v_smfmac_f32_32x32x32_bf16 v[64:79], v[144:147], v[32:39], v4
    v_exp_f32 v42, v42
    v_exp_f32 v43, v43
    v_exp_f32 v44, v44
    v_exp_f32 v45, v45
    v_exp_f32 v46, v46
    v_exp_f32 v47, v47
    v_exp_f32 v48, v48
    v_exp_f32 v49, v49
    v_smfmac_f32_32x32x32_bf16 v[64:79], v[148:151], v[40:47], v4
    v_exp_f32 v50, v50
    v_exp_f32 v51, v51
    v_exp_f32 v52, v52
    v_mfma_f32_32x32x16_bf16 v[32:47], v[208:211], v[224:227], 0
    v_exp_f32 v53, v53
    v_exp_f32 v54, v54
    v_exp_f32 v55, v55
    v_exp_f32 v56, v56
    v_exp_f32 v57, v57
    v_smfmac_f32_32x32x32_bf16 v[64:79], v[152:155], v[48:55], v4
    v_exp_f32 v58, v58
    v_exp_f32 v59, v59
    v_exp_f32 v60, v60
    v_exp_f32 v61, v61
    v_exp_f32 v62, v62
    v_exp_f32 v63, v63
    v_exp_f32 v32, v32
    v_exp_f32 v33, v33
    v_smfmac_f32_32x32x32_bf16 v[64:79], v[156:159], v[56:63], v4
    v_exp_f32 v34, v34
    v_exp_f32 v35, v35
    v_exp_f32 v36, v36
    v_mfma_f32_32x32x16_bf16 v[48:63], v[212:215], v[224:227], 0
    v_exp_f32 v37, v37
    v_exp_f32 v38, v38
    v_exp_f32 v39, v39
    v_exp_f32 v40, v40
    v_exp_f32 v41, v41
    v_smfmac_f32_32x32x32_bf16 v[64:79], v[160:163], v[32:39], v4
    v_exp_f32 v42, v42
    v_exp_f32 v43, v43
    s_waitcnt lgkmcnt(0)
    s_barrier
    s_setprio 3
    buffer_load_dwordx4 v[112:115], v2, s[20:23], s78 offen offset:2048 sc1
    v_exp_f32 v44, v44
    v_exp_f32 v45, v45
    v_exp_f32 v46, v46
    v_exp_f32 v47, v47
    v_exp_f32 v48, v48
    v_exp_f32 v49, v49
    v_smfmac_f32_32x32x32_bf16 v[64:79], v[164:167], v[40:47], v4
    v_exp_f32 v50, v50
    v_exp_f32 v51, v51
    v_exp_f32 v52, v52
    v_mfma_f32_32x32x16_bf16 v[32:47], v[216:219], v[224:227], 0
    v_exp_f32 v53, v53
    v_exp_f32 v54, v54
    ds_read_b128 v[80:83], v7 offset:18432
    v_exp_f32 v55, v55
    v_exp_f32 v56, v56
    v_exp_f32 v57, v57
    v_smfmac_f32_32x32x32_bf16 v[64:79], v[168:171], v[48:55], v4
    v_exp_f32 v58, v58
    v_exp_f32 v59, v59
    buffer_load_dwordx4 v[116:119], v2, s[20:23], s78 offen offset:3072 sc1
    v_exp_f32 v60, v60
    v_exp_f32 v61, v61
    v_exp_f32 v62, v62
    v_exp_f32 v63, v63
    s_setprio 2
    v_exp_f32 v32, v32
    v_exp_f32 v33, v33
    v_smfmac_f32_32x32x32_bf16 v[64:79], v[172:175], v[56:63], v4
    v_exp_f32 v34, v34
    v_exp_f32 v35, v35
    v_exp_f32 v36, v36
    v_mfma_f32_32x32x16_bf16 v[48:63], v[220:223], v[224:227], 0
    v_exp_f32 v37, v37
    v_exp_f32 v38, v38
    ds_read_b128 v[84:87], v7 offset:19456
    v_exp_f32 v39, v39
    v_exp_f32 v40, v40
    v_exp_f32 v41, v41
    v_smfmac_f32_32x32x32_bf16 v[64:79], v[176:179], v[32:39], v4
    v_exp_f32 v42, v42
    v_exp_f32 v43, v43
    s_add_u32 s78, s74, 12288
    buffer_load_dwordx4 v[120:123], v2, s[20:23], s78 offen offset:0 sc1
    v_exp_f32 v44, v44
    v_exp_f32 v45, v45
    v_exp_f32 v46, v46
    v_exp_f32 v47, v47
    v_exp_f32 v48, v48
    v_exp_f32 v49, v49
    v_smfmac_f32_32x32x32_bf16 v[64:79], v[180:183], v[40:47], v4
    v_exp_f32 v50, v50
    v_exp_f32 v51, v51
    v_exp_f32 v52, v52
    s_waitcnt vmcnt(5)
    v_mfma_f32_32x32x16_bf16 v[32:47], v[192:195], v[228:231], 0
    v_exp_f32 v53, v53
    v_exp_f32 v54, v54
    ds_read_b32 v88, v3 offset:20480
    v_exp_f32 v55, v55
    v_exp_f32 v56, v56
    v_exp_f32 v57, v57
    v_smfmac_f32_32x32x32_bf16 v[64:79], v[184:187], v[48:55], v4
    v_exp_f32 v58, v58
    v_exp_f32 v59, v59
    buffer_load_dwordx4 v[124:127], v2, s[20:23], s78 offen offset:1024 sc1
    v_exp_f32 v60, v60
    v_exp_f32 v61, v61
    v_exp_f32 v62, v62
    v_exp_f32 v63, v63
    s_setprio 1
    v_exp_f32 v32, v32
    v_exp_f32 v33, v33
    v_smfmac_f32_32x32x32_bf16 v[64:79], v[188:191], v[56:63], v4
    v_exp_f32 v34, v34
    v_exp_f32 v35, v35
    v_exp_f32 v36, v36
    v_mfma_f32_32x32x16_bf16 v[48:63], v[196:199], v[228:231], 0
    v_exp_f32 v37, v37
    v_exp_f32 v38, v38
    v_exp_f32 v39, v39
    v_exp_f32 v40, v40
    v_exp_f32 v41, v41
    s_waitcnt lgkmcnt(0)
    v_smfmac_f32_32x32x32_bf16 v[80:95], v[128:131], v[32:39], v4
    v_exp_f32 v42, v42
    v_exp_f32 v43, v43
    buffer_load_dwordx4 v[232:235], v2, s[20:23], s78 offen offset:2048 sc1
    s_cmp_eq_u32 s72, 3
    s_cselect_b32 s48, 19, 20
    s_lshl_b32 s48, s48, 10
    s_add_u32 s48, s48, s74
    buffer_load_dwordx4 v[192:195], v2, s[20:23], s48 offen sc1
    v_exp_f32 v44, v44
    v_exp_f32 v45, v45
    ds_write_b128 v5, v[64:67] offset:0
    v_exp_f32 v46, v46
    v_exp_f32 v47, v47
    v_exp_f32 v48, v48
    v_exp_f32 v49, v49
    v_smfmac_f32_32x32x32_bf16 v[80:95], v[132:135], v[40:47], v4
    v_exp_f32 v50, v50
    v_exp_f32 v51, v51
    v_exp_f32 v52, v52
    v_mfma_f32_32x32x16_bf16 v[32:47], v[200:203], v[228:231], 0
    v_exp_f32 v53, v53
    v_exp_f32 v54, v54
    ds_write_b128 v5, v[68:71] offset:1024
    v_exp_f32 v55, v55
    v_exp_f32 v56, v56
    v_exp_f32 v57, v57
    v_smfmac_f32_32x32x32_bf16 v[80:95], v[136:139], v[48:55], v4
    v_exp_f32 v58, v58
    v_exp_f32 v59, v59
    buffer_load_dwordx4 v[236:239], v2, s[20:23], s78 offen offset:3072 sc1
    s_sub_u32 s48, s36, 1
    s_and_b32 s48, s48, 7
    s_mul_i32 s48, s48, 2304
    s_add_u32 s48, s48, 126976
    v_add_u32 v7, s48, v2
    v_lshl_add_u32 v3, v1, 2, s48
    s_cmp_eq_u32 s72, 3
    s_cselect_b32 s48, 19, 21
    s_lshl_b32 s48, s48, 10
    s_add_u32 s48, s48, s74
    buffer_load_dwordx4 v[196:199], v2, s[20:23], s48 offen sc1
    v_exp_f32 v60, v60
    v_exp_f32 v61, v61
    ds_write_b32 v6, v72 offset:2048
    v_exp_f32 v62, v62
    v_exp_f32 v63, v63
    s_setprio 0
    v_exp_f32 v32, v32
    v_exp_f32 v33, v33
    v_smfmac_f32_32x32x32_bf16 v[80:95], v[140:143], v[56:63], v4
    v_exp_f32 v34, v34
    v_exp_f32 v35, v35
    v_exp_f32 v36, v36
    v_mfma_f32_32x32x16_bf16 v[48:63], v[204:207], v[228:231], 0
    v_exp_f32 v37, v37
    v_exp_f32 v38, v38
    v_exp_f32 v39, v39
    v_exp_f32 v40, v40
    v_exp_f32 v41, v41
    v_smfmac_f32_32x32x32_bf16 v[80:95], v[144:147], v[32:39], v4
    v_exp_f32 v42, v42
    v_exp_f32 v43, v43
    v_exp_f32 v44, v44
    v_exp_f32 v45, v45
    v_exp_f32 v46, v46
    v_exp_f32 v47, v47
    v_exp_f32 v48, v48
    v_exp_f32 v49, v49
    v_smfmac_f32_32x32x32_bf16 v[80:95], v[148:151], v[40:47], v4
    v_exp_f32 v50, v50
    v_exp_f32 v51, v51
    v_exp_f32 v52, v52
    v_mfma_f32_32x32x16_bf16 v[32:47], v[208:211], v[228:231], 0
    v_exp_f32 v53, v53
    v_exp_f32 v54, v54
    v_exp_f32 v55, v55
    v_exp_f32 v56, v56
    v_exp_f32 v57, v57
    v_smfmac_f32_32x32x32_bf16 v[80:95], v[152:155], v[48:55], v4
    v_exp_f32 v58, v58
    v_exp_f32 v59, v59
    v_exp_f32 v60, v60
    v_exp_f32 v61, v61
    v_exp_f32 v62, v62
    v_exp_f32 v63, v63
    v_exp_f32 v32, v32
    v_exp_f32 v33, v33
    v_smfmac_f32_32x32x32_bf16 v[80:95], v[156:159], v[56:63], v4
    v_exp_f32 v34, v34
    v_exp_f32 v35, v35
    v_exp_f32 v36, v36
    v_mfma_f32_32x32x16_bf16 v[48:63], v[212:215], v[228:231], 0
    v_exp_f32 v37, v37
    v_exp_f32 v38, v38
    v_exp_f32 v39, v39
    v_exp_f32 v40, v40
    v_exp_f32 v41, v41
    v_smfmac_f32_32x32x32_bf16 v[80:95], v[160:163], v[32:39], v4
    v_exp_f32 v42, v42
    v_exp_f32 v43, v43
    s_waitcnt lgkmcnt(0)
    s_waitcnt vmcnt(22)
    s_barrier
    s_setprio 3
    s_add_u32 s78, s74, 16384
    buffer_load_dwordx4 v[240:243], v2, s[20:23], s78 offen offset:0 sc1
    s_lshl_b32 s48, s62, 3
    s_add_u32 s48, s48, s36
    s_lshl_b32 s48, s48, 13
    s_lshl_b32 s49, s63, 7
    s_add_u32 s48, s48, s49
    v_lshrrev_b32 v6, 3, v1
    v_lshlrev_b32 v6, 10, v6
    v_and_b32 v200, 7, v1
    v_lshlrev_b32 v200, 4, v200
    v_add3_u32 v6, v6, v200, s48
    buffer_load_dwordx4 v[200:203], v6, s[8:11], 0 offen
    v_exp_f32 v44, v44
    v_exp_f32 v45, v45
    v_exp_f32 v46, v46
    v_exp_f32 v47, v47
    v_exp_f32 v48, v48
    v_exp_f32 v49, v49
    v_smfmac_f32_32x32x32_bf16 v[80:95], v[164:167], v[40:47], v4
    v_exp_f32 v50, v50
    v_exp_f32 v51, v51
    v_exp_f32 v52, v52
    v_mfma_f32_32x32x16_bf16 v[32:47], v[216:219], v[228:231], 0
    v_exp_f32 v53, v53
    v_exp_f32 v54, v54
    ds_read_b128 v[64:67], v7 offset:0
    v_exp_f32 v55, v55
    v_exp_f32 v56, v56
    v_exp_f32 v57, v57
    v_smfmac_f32_32x32x32_bf16 v[80:95], v[168:171], v[48:55], v4
    v_exp_f32 v58, v58
    v_exp_f32 v59, v59
    buffer_load_dwordx4 v[244:247], v2, s[20:23], s78 offen offset:1024 sc1
    s_add_u32 m0, s93, 147456
    s_mov_b32 s49, 245760
    buffer_load_dwordx4 v0, s[24:27], s49 offen  lds
    v_exp_f32 v60, v60
    v_exp_f32 v61, v61
    v_exp_f32 v62, v62
    v_exp_f32 v63, v63
    s_setprio 2
    v_exp_f32 v32, v32
    v_exp_f32 v33, v33
    v_smfmac_f32_32x32x32_bf16 v[80:95], v[172:175], v[56:63], v4
    v_exp_f32 v34, v34
    v_exp_f32 v35, v35
    v_exp_f32 v36, v36
    v_mfma_f32_32x32x16_bf16 v[48:63], v[220:223], v[228:231], 0
    v_exp_f32 v37, v37
    v_exp_f32 v38, v38
    ds_read_b128 v[68:71], v7 offset:1024
    v_exp_f32 v39, v39
    v_exp_f32 v40, v40
    v_exp_f32 v41, v41
    v_smfmac_f32_32x32x32_bf16 v[80:95], v[176:179], v[32:39], v4
    v_exp_f32 v42, v42
    v_exp_f32 v43, v43
    buffer_load_dwordx4 v[248:251], v2, s[20:23], s78 offen offset:2048 sc1
    s_add_u32 m0, s93, 155648
    s_mov_b32 s49, 262144
    buffer_load_dwordx4 v0, s[24:27], s49 offen  lds
    v_exp_f32 v44, v44
    v_exp_f32 v45, v45
    v_exp_f32 v46, v46
    v_exp_f32 v47, v47
    v_exp_f32 v48, v48
    v_exp_f32 v49, v49
    v_smfmac_f32_32x32x32_bf16 v[80:95], v[180:183], v[40:47], v4
    v_exp_f32 v50, v50
    v_exp_f32 v51, v51
    v_exp_f32 v52, v52
    v_exp_f32 v53, v53
    v_exp_f32 v54, v54
    ds_read_b32 v72, v3 offset:2048
    v_exp_f32 v55, v55
    v_exp_f32 v56, v56
    v_exp_f32 v57, v57
    v_smfmac_f32_32x32x32_bf16 v[80:95], v[184:187], v[48:55], v4
    v_exp_f32 v58, v58
    v_exp_f32 v59, v59
    buffer_load_dwordx4 v[252:255], v2, s[20:23], s78 offen offset:3072 sc1
    v_exp_f32 v60, v60
    v_exp_f32 v61, v61
    v_exp_f32 v62, v62
    v_exp_f32 v63, v63
    s_setprio 1
    s_nop 1
    v_smfmac_f32_32x32x32_bf16 v[80:95], v[188:191], v[56:63], v4
    s_setprio 0
    s_waitcnt lgkmcnt(0)
    s_mul_i32 s48, s72, 352
    s_lshl_b32 s49, s73, 3
    s_add_u32 s48, s48, s49
    s_lshl_b32 s49, s36, 3
    s_sub_u32 s48, s49, s48
    s_lshl_b32 s48, s48, 10
    v_add_u32 v5, s48, v0
    v_lshrrev_b32 v61, 5, v1
    v_bfe_u32 v62, v1, 2, 2
    v_lshl_add_u32 v62, v61, 3, v62
    v_lshlrev_b32 v58, 9, v61
    v_lshlrev_b32 v56, 7, v62
    v_bfe_u32 v62, v1, 3, 1
    v_lshl_add_u32 v56, v62, 6, v56
    v_bfe_u32 v62, v1, 4, 1
    v_lshl_add_u32 v56, v62, 5, v56
    v_and_b32 v62, 3, v1
    v_lshl_add_u32 v56, v62, 3, v56
    s_lshl_b32 s49, s72, 11
    v_add_u32 v56, s49, v56
    v_xor_b32 v57, 64, v56
    s_mov_b32 s50, 0x27800000
    s_mov_b32 s51, 0x57800000
    v_add_f32 v88, v88, v72
    v_cmp_lt_f32 s[52:53], s50, v88
    v_cmp_gt_f32 vcc, s51, v88
    v_add_f32 v80, v80, v64
    v_add_f32 v81, v81, v65
    v_add_f32 v82, v82, v66
    v_add_f32 v83, v83, v67
    v_add_f32 v84, v84, v68
    v_add_f32 v85, v85, v69
    v_add_f32 v86, v86, v70
    v_add_f32 v87, v87, v71
    s_and_b64 vcc, vcc, s[52:53]
    s_cmp_eq_u64 vcc, -1
    s_cbranch_scc0 L_slow_15
L_fin_16:
    v_rcp_f32 v88, v88
    ds_read_b64_tr_b16 v[32:33], v56 offset:0
    ds_read_b64_tr_b16 v[34:35], v56 offset:512
    ds_read_b64_tr_b16 v[36:37], v57 offset:0
    ds_read_b64_tr_b16 v[38:39], v57 offset:512
    ds_read_b64_tr_b16 v[40:41], v56 offset:8192
    ds_read_b64_tr_b16 v[42:43], v56 offset:8704
    ds_read_b64_tr_b16 v[44:45], v57 offset:8192
    ds_read_b64_tr_b16 v[46:47], v57 offset:8704
    v_pk_mul_f32 v[80:81], v[80:81], v[88:89] op_sel_hi:[1,0]
    v_pk_mul_f32 v[82:83], v[82:83], v[88:89] op_sel_hi:[1,0]
    v_pk_mul_f32 v[84:85], v[84:85], v[88:89] op_sel_hi:[1,0]
    v_pk_mul_f32 v[86:87], v[86:87], v[88:89] op_sel_hi:[1,0]
    v_cvt_pk_bf16_f32 v64, v80, v81
    v_cvt_pk_bf16_f32 v65, v82, v83
    v_cvt_pk_bf16_f32 v66, v84, v85
    v_cvt_pk_bf16_f32 v67, v86, v87
    buffer_store_dwordx4 v[64:67], v2, s[20:23], s75 offen sc1
    s_waitcnt vmcnt(16)
    s_waitcnt lgkmcnt(4)
    v_mfma_f32_32x32x16_bf16 v[64:79], v[32:35], v[8:11], 0
    ds_read_b64_tr_b16 v[48:49], v56 offset:16384
    ds_read_b64_tr_b16 v[50:51], v56 offset:16896
    v_mfma_f32_32x32x16_bf16 v[80:95], v[36:39], v[8:11], 0
    ds_read_b64_tr_b16 v[52:53], v57 offset:16384
    ds_read_b64_tr_b16 v[54:55], v57 offset:16896
    s_lshl_b32 s49, s36, 3
    v_lshrrev_b32 v61, 3, v1
    v_add_u32 v61, s49, v61
    v_and_b32 v62, 7, v1
    v_lshlrev_b32 v63, 4, v62
    v_mul_u32_u24 v7, 144, v61
    s_mov_b32 s52, 81920
    v_add3_u32 v7, v7, v63, s52
    s_waitcnt lgkmcnt(4)
    v_mfma_f32_32x32x16_bf16 v[64:79], v[40:43], v[12:15], v[64:79]
    ds_read_b64_tr_b16 v[32:33], v56 offset:24576
    ds_read_b64_tr_b16 v[34:35], v56 offset:25088
    v_mfma_f32_32x32x16_bf16 v[80:95], v[44:47], v[12:15], v[80:95]
    ds_read_b64_tr_b16 v[36:37], v57 offset:24576
    ds_read_b64_tr_b16 v[38:39], v57 offset:25088
    v_and_b32 v62, 31, v1
    s_lshl_b32 s49, s73, 5
    v_add_u32 v62, s49, v62
    v_mul_u32_u24 v3, 144, v62
    v_lshrrev_b32 v61, 5, v1
    s_mul_i32 s48, s72, 9216
    s_add_u32 s48, s48, 81920
    v_lshl_add_u32 v3, v61, 3, v3
    v_add_u32 v3, s48, v3
    s_barrier
    s_waitcnt lgkmcnt(4)
    v_mfma_f32_32x32x16_bf16 v[64:79], v[48:51], v[16:19], v[64:79]
    ds_read_b64_tr_b16 v[40:41], v56 offset:32768
    ds_read_b64_tr_b16 v[42:43], v56 offset:33280
    s_add_u32 m0, s93, 122880
    s_mov_b32 s49, 278528
    buffer_load_dwordx4 v0, s[24:27], s49 offen  lds
    v_mfma_f32_32x32x16_bf16 v[80:95], v[52:55], v[16:19], v[80:95]
    ds_read_b64_tr_b16 v[44:45], v57 offset:32768
    ds_read_b64_tr_b16 v[46:47], v57 offset:33280
    s_waitcnt lgkmcnt(4)
    v_mfma_f32_32x32x16_bf16 v[64:79], v[32:35], v[20:23], v[64:79]
    ds_read_b64_tr_b16 v[48:49], v56 offset:40960
    ds_read_b64_tr_b16 v[50:51], v56 offset:41472
    s_add_u32 m0, s93, 131072
    s_mov_b32 s49, 294912
    buffer_load_dwordx4 v0, s[24:27], s49 offen  lds
    v_mfma_f32_32x32x16_bf16 v[80:95], v[36:39], v[20:23], v[80:95]
    ds_read_b64_tr_b16 v[52:53], v57 offset:40960
    ds_read_b64_tr_b16 v[54:55], v57 offset:41472
    s_waitcnt lgkmcnt(4)
    v_mfma_f32_32x32x16_bf16 v[64:79], v[40:43], v[24:27], v[64:79]
    ds_read_b64_tr_b16 v[32:33], v56 offset:49152
    ds_read_b64_tr_b16 v[34:35], v56 offset:49664
    s_add_u32 m0, s93, 139264
    s_mov_b32 s49, 311296
    buffer_load_dwordx4 v0, s[24:27], s49 offen  lds
    v_mfma_f32_32x32x16_bf16 v[80:95], v[44:47], v[24:27], v[80:95]
    ds_read_b64_tr_b16 v[36:37], v57 offset:49152
    ds_read_b64_tr_b16 v[38:39], v57 offset:49664
    s_waitcnt lgkmcnt(4)
    v_mfma_f32_32x32x16_bf16 v[64:79], v[48:51], v[28:31], v[64:79]
    ds_read_b64_tr_b16 v[40:41], v56 offset:57344
    ds_read_b64_tr_b16 v[42:43], v56 offset:57856
    s_add_u32 m0, s93, 0
    s_mov_b32 s49, 327680
    buffer_load_dwordx4 v0, s[24:27], s49 offen  lds
    v_mfma_f32_32x32x16_bf16 v[80:95], v[52:55], v[28:31], v[80:95]
    ds_read_b64_tr_b16 v[44:45], v57 offset:57344
    ds_read_b64_tr_b16 v[46:47], v57 offset:57856
    s_barrier
    s_waitcnt lgkmcnt(4)
    v_mfma_f32_32x32x16_bf16 v[64:79], v[32:35], v[96:99], v[64:79]
    v_add_u32 v56, 0x10000, v56
    v_add_u32 v57, 0x10000, v57
    ds_read_b64_tr_b16 v[48:49], v56 offset:0
    ds_read_b64_tr_b16 v[50:51], v56 offset:512
    s_add_u32 m0, s93, 8192
    s_mov_b32 s49, 344064
    buffer_load_dwordx4 v0, s[24:27], s49 offen  lds
    v_mfma_f32_32x32x16_bf16 v[80:95], v[36:39], v[96:99], v[80:95]
    ds_read_b64_tr_b16 v[52:53], v57 offset:0
    ds_read_b64_tr_b16 v[54:55], v57 offset:512
    s_waitcnt lgkmcnt(4)
    v_mfma_f32_32x32x16_bf16 v[64:79], v[40:43], v[100:103], v[64:79]
    ds_read_b64_tr_b16 v[32:33], v56 offset:8192
    ds_read_b64_tr_b16 v[34:35], v56 offset:8704
    s_add_u32 m0, s93, 16384
    s_mov_b32 s49, 0
    buffer_load_dwordx4 v5, s[28:31], s49 offen  lds
    v_mfma_f32_32x32x16_bf16 v[80:95], v[44:47], v[100:103], v[80:95]
    ds_read_b64_tr_b16 v[36:37], v57 offset:8192
    ds_read_b64_tr_b16 v[38:39], v57 offset:8704
    s_lshl_b32 s48, s62, 1
    s_add_u32 s48, s48, s73
    s_lshl_b32 s48, s48, 5
    s_lshl_b32 s50, s72, 3
    s_add_u32 s53, s48, s50
    s_mov_b32 s46, 0x3f80
    s_mov_b32 s47, 0x3f800000
    s_lshl_b32 s53, s53, 10
    s_add_u32 s53, s53, 6291456
    s_add_u32 s51, s53, 4096
    s_waitcnt lgkmcnt(4)
    v_mfma_f32_32x32x16_bf16 v[64:79], v[48:51], v[104:107], v[64:79]
    ds_read_b64_tr_b16 v[40:41], v56 offset:16384
    ds_read_b64_tr_b16 v[42:43], v56 offset:16896
    s_add_u32 m0, s93, 24576
    s_mov_b32 s49, 65536
    buffer_load_dwordx4 v5, s[28:31], s49 offen  lds
    v_mfma_f32_32x32x16_bf16 v[80:95], v[52:55], v[104:107], v[80:95]
    ds_read_b64_tr_b16 v[44:45], v57 offset:16384
    ds_read_b64_tr_b16 v[46:47], v57 offset:16896
    s_waitcnt lgkmcnt(4)
    v_mfma_f32_32x32x16_bf16 v[64:79], v[32:35], v[108:111], v[64:79]
    ds_read_b64_tr_b16 v[48:49], v56 offset:24576
    ds_read_b64_tr_b16 v[50:51], v56 offset:25088
    s_add_u32 m0, s93, 32768
    s_mov_b32 s49, 131072
    buffer_load_dwordx4 v5, s[28:31], s49 offen  lds
    v_mfma_f32_32x32x16_bf16 v[80:95], v[36:39], v[108:111], v[80:95]
    ds_read_b64_tr_b16 v[52:53], v57 offset:24576
    ds_read_b64_tr_b16 v[54:55], v57 offset:25088
    s_waitcnt vmcnt(5)
    s_barrier
    s_waitcnt lgkmcnt(4)
    v_mfma_f32_32x32x16_bf16 v[64:79], v[40:43], v[112:115], v[64:79]
    ds_read_b64_tr_b16 v[32:33], v56 offset:32768
    ds_read_b64_tr_b16 v[34:35], v56 offset:33280
    s_add_u32 m0, s93, 40960
    s_mov_b32 s49, 196608
    buffer_load_dwordx4 v5, s[28:31], s49 offen  lds
    v_mfma_f32_32x32x16_bf16 v[80:95], v[44:47], v[112:115], v[80:95]
    ds_read_b64_tr_b16 v[36:37], v57 offset:32768
    ds_read_b64_tr_b16 v[38:39], v57 offset:33280
    s_waitcnt lgkmcnt(4)
    v_mfma_f32_32x32x16_bf16 v[64:79], v[48:51], v[116:119], v[64:79]
    ds_read_b64_tr_b16 v[40:41], v56 offset:40960
    ds_read_b64_tr_b16 v[42:43], v56 offset:41472
    s_add_u32 m0, s93, 49152
    s_mov_b32 s49, 262144
    buffer_load_dwordx4 v5, s[28:31], s49 offen  lds
    v_mfma_f32_32x32x16_bf16 v[80:95], v[52:55], v[116:119], v[80:95]
    ds_read_b64_tr_b16 v[44:45], v57 offset:40960
    ds_read_b64_tr_b16 v[46:47], v57 offset:41472
    s_waitcnt lgkmcnt(4)
    v_mfma_f32_32x32x16_bf16 v[64:79], v[32:35], v[120:123], v[64:79]
    ds_read_b64_tr_b16 v[48:49], v56 offset:49152
    ds_read_b64_tr_b16 v[50:51], v56 offset:49664
    s_add_u32 m0, s93, 57344
    s_mov_b32 s49, 327680
    buffer_load_dwordx4 v5, s[28:31], s49 offen  lds
    v_mfma_f32_32x32x16_bf16 v[80:95], v[36:39], v[120:123], v[80:95]
    ds_read_b64_tr_b16 v[52:53], v57 offset:49152
    ds_read_b64_tr_b16 v[54:55], v57 offset:49664
    s_waitcnt lgkmcnt(4)
    v_mfma_f32_32x32x16_bf16 v[64:79], v[40:43], v[124:127], v[64:79]
    v_add_u32 v56, 0x10000, v56
    v_add_u32 v57, 0x10000, v57
    ds_read_b64_tr_b16 v[32:33], v56 offset:16384
    ds_read_b64_tr_b16 v[34:35], v56 offset:16896
    s_add_u32 m0, s93, 65536
    s_mov_b32 s49, 393216
    buffer_load_dwordx4 v5, s[28:31], s49 offen  lds
    v_mfma_f32_32x32x16_bf16 v[80:95], v[44:47], v[124:127], v[80:95]
    ds_read_b64_tr_b16 v[36:37], v57 offset:16384
    ds_read_b64_tr_b16 v[38:39], v57 offset:16896
    s_waitcnt lgkmcnt(4)
    v_mfma_f32_32x32x16_bf16 v[64:79], v[48:51], v[232:235], v[64:79]
    ds_read_b64_tr_b16 v[40:41], v56 offset:24576
    ds_read_b64_tr_b16 v[42:43], v56 offset:25088
    s_add_u32 m0, s93, 73728
    s_mov_b32 s49, 458752
    buffer_load_dwordx4 v5, s[28:31], s49 offen  lds
    v_mfma_f32_32x32x16_bf16 v[80:95], v[52:55], v[232:235], v[80:95]
    ds_read_b64_tr_b16 v[44:45], v57 offset:24576
    ds_read_b64_tr_b16 v[46:47], v57 offset:25088
    s_waitcnt lgkmcnt(4)
    v_mfma_f32_32x32x16_bf16 v[64:79], v[32:35], v[236:239], v[64:79]
    v_add_u32 v56, 0xffff0000, v56
    v_add_u32 v57, 0xffff0000, v57
    ds_read_b64_tr_b16 v[48:49], v56 offset:57344
    ds_read_b64_tr_b16 v[50:51], v56 offset:57856
    buffer_load_dwordx4 v[128:131], v2, s[20:23], s53 offen offset:0 sc1
    v_mfma_f32_32x32x16_bf16 v[80:95], v[36:39], v[236:239], v[80:95]
    ds_read_b64_tr_b16 v[52:53], v57 offset:57344
    ds_read_b64_tr_b16 v[54:55], v57 offset:57856
    s_waitcnt lgkmcnt(4)
    v_mfma_f32_32x32x16_bf16 v[64:79], v[40:43], v[240:243], v[64:79]
    v_add_u32 v56, 0x10000, v56
    v_add_u32 v57, 0x10000, v57
    ds_read_b64_tr_b16 v[32:33], v56 offset:0
    ds_read_b64_tr_b16 v[34:35], v56 offset:512
    buffer_load_dwordx4 v[132:135], v2, s[20:23], s53 offen offset:1024 sc1
    v_mfma_f32_32x32x16_bf16 v[80:95], v[44:47], v[240:243], v[80:95]
    ds_read_b64_tr_b16 v[36:37], v57 offset:0
    ds_read_b64_tr_b16 v[38:39], v57 offset:512
    s_waitcnt lgkmcnt(4)
    v_mfma_f32_32x32x16_bf16 v[64:79], v[48:51], v[244:247], v[64:79]
    ds_read_b64_tr_b16 v[40:41], v56 offset:8192
    ds_read_b64_tr_b16 v[42:43], v56 offset:8704
    buffer_load_dwordx4 v[136:139], v2, s[20:23], s53 offen offset:2048 sc1
    v_mfma_f32_32x32x16_bf16 v[80:95], v[52:55], v[244:247], v[80:95]
    ds_read_b64_tr_b16 v[44:45], v57 offset:8192
    ds_read_b64_tr_b16 v[46:47], v57 offset:8704
    s_waitcnt vmcnt(3)
    s_barrier
    s_waitcnt lgkmcnt(4)
    v_mfma_f32_32x32x16_bf16 v[64:79], v[32:35], v[248:251], v[64:79]
    v_add_u32 v56, 0xfffe0000, v56
    v_add_u32 v57, 0xfffe0000, v57
    ds_read_b64_tr_b16 v[48:49], v56 offset:0
    ds_read_b64_tr_b16 v[50:51], v56 offset:512
    buffer_load_dwordx4 v[140:143], v2, s[20:23], s53 offen offset:3072 sc1
    v_mfma_f32_32x32x16_bf16 v[80:95], v[36:39], v[248:251], v[80:95]
    ds_read_b64_tr_b16 v[52:53], v57 offset:0
    ds_read_b64_tr_b16 v[54:55], v57 offset:512
    s_waitcnt lgkmcnt(4)
    v_mfma_f32_32x32x16_bf16 v[64:79], v[40:43], v[252:255], v[64:79]
    ds_read_b64_tr_b16 v[32:33], v56 offset:8192
    ds_read_b64_tr_b16 v[34:35], v56 offset:8704
    buffer_load_dwordx4 v[144:147], v2, s[20:23], s51 offen offset:0 sc1
    v_mfma_f32_32x32x16_bf16 v[80:95], v[44:47], v[252:255], v[80:95]
    ds_read_b64_tr_b16 v[36:37], v57 offset:8192
    ds_read_b64_tr_b16 v[38:39], v57 offset:8704
    s_waitcnt lgkmcnt(4)
    v_mfma_f32_32x32x16_bf16 v[64:79], v[48:51], v[192:195], v[64:79]
    s_mul_i32 s48, s72, 14336
    v_sub_u32 v58, s48, v58
    v_add_u32 v56, v58, v56
    v_add_u32 v57, v58, v57
    ds_read_b64_tr_b16 v[40:41], v56 offset:16384
    ds_read_b64_tr_b16 v[42:43], v56 offset:17408
    buffer_load_dwordx4 v[148:151], v2, s[20:23], s51 offen offset:1024 sc1
    v_mfma_f32_32x32x16_bf16 v[80:95], v[52:55], v[192:195], v[80:95]
    ds_read_b64_tr_b16 v[44:45], v57 offset:16384
    ds_read_b64_tr_b16 v[46:47], v57 offset:17408
    s_waitcnt lgkmcnt(4)
    v_mfma_f32_32x32x16_bf16 v[64:79], v[32:35], v[196:199], v[64:79]
    ds_read_b64_tr_b16 v[48:49], v56 offset:18432
    ds_read_b64_tr_b16 v[50:51], v56 offset:19456
    buffer_load_dwordx4 v[152:155], v2, s[20:23], s51 offen offset:2048 sc1
    v_mfma_f32_32x32x16_bf16 v[80:95], v[36:39], v[196:199], v[80:95]
    ds_read_b64_tr_b16 v[52:53], v57 offset:18432
    ds_read_b64_tr_b16 v[54:55], v57 offset:19456
    s_waitcnt vmcnt(6)
    v_max3_u32 v61, v128, v129, v130
    v_max_u32 v61, v61, v131
    v_cmp_eq_u32 vcc, -1, v61
    s_cbranch_vccnz L_os_17
L_ob_18:
    s_waitcnt lgkmcnt(4)
    v_mfma_f32_32x32x16_bf16 v[160:175], v[40:43], v[128:131], 0
    ds_read_b64_tr_b16 v[32:33], v56 offset:20480
    ds_read_b64_tr_b16 v[34:35], v56 offset:21504
    buffer_load_dwordx4 v[156:159], v2, s[20:23], s51 offen offset:3072 sc1
    v_mfma_f32_32x32x16_bf16 v[176:191], v[44:47], v[128:131], 0
    ds_read_b64_tr_b16 v[36:37], v57 offset:20480
    ds_read_b64_tr_b16 v[38:39], v57 offset:21504
    s_waitcnt vmcnt(6)
    v_max3_u32 v61, v132, v133, v134
    v_max_u32 v61, v61, v135
    v_cmp_eq_u32 vcc, -1, v61
    s_cbranch_vccnz L_os_19
L_ob_20:
    s_waitcnt lgkmcnt(4)
    v_mfma_f32_32x32x16_bf16 v[160:175], v[48:51], v[132:135], v[160:175]
    ds_read_b64_tr_b16 v[40:41], v56 offset:22528
    ds_read_b64_tr_b16 v[42:43], v56 offset:23552
    v_cvt_pk_bf16_f32 v8, v64, v65
    v_cvt_pk_bf16_f32 v9, v66, v67
    ds_write_b64 v3, v[8:9] offset:0
    v_cvt_pk_bf16_f32 v10, v68, v69
    v_cvt_pk_bf16_f32 v11, v70, v71
    ds_write_b64 v3, v[10:11] offset:16
    v_mfma_f32_32x32x16_bf16 v[176:191], v[52:55], v[132:135], v[176:191]
    ds_read_b64_tr_b16 v[44:45], v57 offset:22528
    ds_read_b64_tr_b16 v[46:47], v57 offset:23552
    v_cvt_pk_bf16_f32 v12, v72, v73
    v_cvt_pk_bf16_f32 v13, v74, v75
    ds_write_b64 v3, v[12:13] offset:32
    v_cvt_pk_bf16_f32 v14, v76, v77
    v_cvt_pk_bf16_f32 v15, v78, v79
    ds_write_b64 v3, v[14:15] offset:48
    s_waitcnt vmcnt(5)
    v_max3_u32 v61, v136, v137, v138
    v_max_u32 v61, v61, v139
    v_cmp_eq_u32 vcc, -1, v61
    s_cbranch_vccnz L_os_21
L_ob_22:
    s_waitcnt lgkmcnt(8)
    v_mfma_f32_32x32x16_bf16 v[160:175], v[32:35], v[136:139], v[160:175]
    ds_read_b64_tr_b16 v[48:49], v56 offset:24576
    ds_read_b64_tr_b16 v[50:51], v56 offset:25600
    v_cvt_pk_bf16_f32 v16, v80, v81
    v_cvt_pk_bf16_f32 v17, v82, v83
    ds_write_b64 v3, v[16:17] offset:64
    v_cvt_pk_bf16_f32 v18, v84, v85
    v_cvt_pk_bf16_f32 v19, v86, v87
    ds_write_b64 v3, v[18:19] offset:80
    v_mfma_f32_32x32x16_bf16 v[176:191], v[36:39], v[136:139], v[176:191]
    ds_read_b64_tr_b16 v[52:53], v57 offset:24576
    ds_read_b64_tr_b16 v[54:55], v57 offset:25600
    s_waitcnt lgkmcnt(10)
    v_cvt_pk_bf16_f32 v20, v88, v89
    v_cvt_pk_bf16_f32 v21, v90, v91
    ds_write_b64 v3, v[20:21] offset:96
    v_cvt_pk_bf16_f32 v22, v92, v93
    v_cvt_pk_bf16_f32 v23, v94, v95
    ds_write_b64 v3, v[22:23] offset:112
    s_waitcnt vmcnt(4)
    v_max3_u32 v61, v140, v141, v142
    v_max_u32 v61, v61, v143
    v_cmp_eq_u32 vcc, -1, v61
    s_cbranch_vccnz L_os_23
L_ob_24:
    s_waitcnt lgkmcnt(10)
    v_mfma_f32_32x32x16_bf16 v[160:175], v[40:43], v[140:143], v[160:175]
    ds_read_b64_tr_b16 v[32:33], v56 offset:26624
    ds_read_b64_tr_b16 v[34:35], v56 offset:27648
    v_mfma_f32_32x32x16_bf16 v[176:191], v[44:47], v[140:143], v[176:191]
    ds_read_b64_tr_b16 v[36:37], v57 offset:26624
    ds_read_b64_tr_b16 v[38:39], v57 offset:27648
    s_waitcnt lgkmcnt(10)
    s_waitcnt lgkmcnt(4)
    s_barrier
    ds_read_b128 v[96:99], v7 offset:0
    ds_read_b128 v[100:103], v7 offset:9216
    ds_read_b128 v[104:107], v7 offset:18432
    ds_read_b128 v[108:111], v7 offset:27648
    s_waitcnt vmcnt(3)
    v_max3_u32 v61, v144, v145, v146
    v_max_u32 v61, v61, v147
    v_cmp_eq_u32 vcc, -1, v61
    s_cbranch_vccnz L_os_25
L_ob_26:
    v_mfma_f32_32x32x16_bf16 v[160:175], v[48:51], v[144:147], v[160:175]
    ds_read_b64_tr_b16 v[40:41], v56 offset:28672
    ds_read_b64_tr_b16 v[42:43], v56 offset:29696
    v_mfma_f32_32x32x16_bf16 v[176:191], v[52:55], v[144:147], v[176:191]
    ds_read_b64_tr_b16 v[44:45], v57 offset:28672
    ds_read_b64_tr_b16 v[46:47], v57 offset:29696
    s_waitcnt vmcnt(2)
    v_max3_u32 v61, v148, v149, v150
    v_max_u32 v61, v61, v151
    v_cmp_eq_u32 vcc, -1, v61
    s_cbranch_vccnz L_os_27
L_ob_28:
    s_waitcnt lgkmcnt(8)
    s_waitcnt lgkmcnt(4)
    v_mfma_f32_32x32x16_bf16 v[160:175], v[32:35], v[148:151], v[160:175]
    ds_read_b64_tr_b16 v[48:49], v56 offset:30720
    ds_read_b64_tr_b16 v[50:51], v56 offset:31744
    v_lshlrev_b32 v64, 16, v96
    v_and_b32 v65, 0xffff0000, v96
    v_lshlrev_b32 v66, 16, v97
    v_and_b32 v67, 0xffff0000, v97
    v_lshlrev_b32 v68, 16, v98
    v_and_b32 v69, 0xffff0000, v98
    v_lshlrev_b32 v70, 16, v99
    v_and_b32 v71, 0xffff0000, v99
    v_lshlrev_b32 v72, 16, v100
    v_mfma_f32_32x32x16_bf16 v[176:191], v[36:39], v[148:151], v[176:191]
    ds_read_b64_tr_b16 v[52:53], v57 offset:30720
    ds_read_b64_tr_b16 v[54:55], v57 offset:31744
    v_and_b32 v73, 0xffff0000, v100
    v_lshlrev_b32 v74, 16, v101
    v_and_b32 v75, 0xffff0000, v101
    v_lshlrev_b32 v76, 16, v102
    v_and_b32 v77, 0xffff0000, v102
    v_lshlrev_b32 v78, 16, v103
    v_and_b32 v79, 0xffff0000, v103
    v_add_f32 v64, v64, v72
    v_add_f32 v65, v65, v73
    s_waitcnt vmcnt(1)
    v_max3_u32 v61, v152, v153, v154
    v_max_u32 v61, v61, v155
    v_cmp_eq_u32 vcc, -1, v61
    s_cbranch_vccnz L_os_29
L_ob_30:
    s_waitcnt lgkmcnt(4)
    v_mfma_f32_32x32x16_bf16 v[160:175], v[40:43], v[152:155], v[160:175]
    v_add_f32 v66, v66, v74
    v_add_f32 v67, v67, v75
    v_add_f32 v68, v68, v76
    v_add_f32 v69, v69, v77
    v_add_f32 v70, v70, v78
    v_add_f32 v71, v71, v79
    v_lshlrev_b32 v72, 16, v104
    v_and_b32 v73, 0xffff0000, v104
    v_lshlrev_b32 v74, 16, v105
    v_mfma_f32_32x32x16_bf16 v[176:191], v[44:47], v[152:155], v[176:191]
    v_and_b32 v75, 0xffff0000, v105
    v_lshlrev_b32 v76, 16, v106
    v_and_b32 v77, 0xffff0000, v106
    v_lshlrev_b32 v78, 16, v107
    v_and_b32 v79, 0xffff0000, v107
    v_add_f32 v64, v64, v72
    v_add_f32 v65, v65, v73
    v_add_f32 v66, v66, v74
    v_add_f32 v67, v67, v75
    s_waitcnt vmcnt(0)
    v_max3_u32 v61, v156, v157, v158
    v_max_u32 v61, v61, v159
    v_cmp_eq_u32 vcc, -1, v61
    s_cbranch_vccnz L_os_31
L_ob_32:
    s_waitcnt lgkmcnt(0)
    v_mfma_f32_32x32x16_bf16 v[160:175], v[48:51], v[156:159], v[160:175]
    v_add_f32 v68, v68, v76
    v_add_f32 v69, v69, v77
    v_add_f32 v70, v70, v78
    v_add_f32 v71, v71, v79
    v_lshlrev_b32 v72, 16, v108
    v_and_b32 v73, 0xffff0000, v108
    v_lshlrev_b32 v74, 16, v109
    v_and_b32 v75, 0xffff0000, v109
    v_lshlrev_b32 v76, 16, v110
    v_mfma_f32_32x32x16_bf16 v[176:191], v[52:55], v[156:159], v[176:191]
    v_and_b32 v77, 0xffff0000, v110
    v_lshlrev_b32 v78, 16, v111
    v_and_b32 v79, 0xffff0000, v111
    v_add_f32 v64, v64, v72
    v_add_f32 v65, v65, v73
    v_add_f32 v66, v66, v74
    v_add_f32 v67, v67, v75
    v_add_f32 v68, v68, v76
    v_add_f32 v69, v69, v77
    v_add_f32 v70, v70, v78
    v_add_f32 v71, v71, v79
    v_mul_f32 v72, 0xbfb8aa3b, v64
    v_mul_f32 v73, 0xbfb8aa3b, v65
    v_mul_f32 v74, 0xbfb8aa3b, v66
    v_mul_f32 v75, 0xbfb8aa3b, v67
    v_mul_f32 v76, 0xbfb8aa3b, v68
    v_mul_f32 v77, 0xbfb8aa3b, v69
    v_mul_f32 v78, 0xbfb8aa3b, v70
    v_mul_f32 v79, 0xbfb8aa3b, v71
    v_exp_f32 v72, v72
    v_exp_f32 v73, v73
    v_cvt_pk_bf16_f32 v8, v160, v161
    v_cvt_pk_bf16_f32 v9, v162, v163
    ds_write_b64 v3, v[8:9] offset:45056
    v_cvt_pk_bf16_f32 v10, v164, v165
    v_cvt_pk_bf16_f32 v11, v166, v167
    ds_write_b64 v3, v[10:11] offset:45072
    v_cvt_pk_bf16_f32 v12, v168, v169
    v_cvt_pk_bf16_f32 v13, v170, v171
    ds_write_b64 v3, v[12:13] offset:45088
    v_cvt_pk_bf16_f32 v14, v172, v173
    v_cvt_pk_bf16_f32 v15, v174, v175
    ds_write_b64 v3, v[14:15] offset:45104
    v_cvt_pk_bf16_f32 v16, v176, v177
    v_cvt_pk_bf16_f32 v17, v178, v179
    ds_write_b64 v3, v[16:17] offset:45120
    v_cvt_pk_bf16_f32 v18, v180, v181
    v_cvt_pk_bf16_f32 v19, v182, v183
    ds_write_b64 v3, v[18:19] offset:45136
    v_cvt_pk_bf16_f32 v20, v184, v185
    v_cvt_pk_bf16_f32 v21, v186, v187
    ds_write_b64 v3, v[20:21] offset:45152
    v_cvt_pk_bf16_f32 v22, v188, v189
    v_cvt_pk_bf16_f32 v23, v190, v191
    ds_write_b64 v3, v[22:23] offset:45168
    v_exp_f32 v74, v74
    v_exp_f32 v75, v75
    v_exp_f32 v76, v76
    v_exp_f32 v77, v77
    v_exp_f32 v78, v78
    v_exp_f32 v79, v79
    v_add_f32 v72, 1.0, v72
    v_add_f32 v73, 1.0, v73
    v_add_f32 v74, 1.0, v74
    v_add_f32 v75, 1.0, v75
    v_add_f32 v76, 1.0, v76
    v_add_f32 v77, 1.0, v77
    v_add_f32 v78, 1.0, v78
    v_add_f32 v79, 1.0, v79
    v_rcp_f32 v72, v72
    v_rcp_f32 v73, v73
    v_rcp_f32 v74, v74
    v_rcp_f32 v75, v75
    v_rcp_f32 v76, v76
    v_rcp_f32 v77, v77
    v_rcp_f32 v78, v78
    v_rcp_f32 v79, v79
    s_nop 0
    v_mul_f32 v64, v64, v72
    v_mul_f32 v65, v65, v73
    v_mul_f32 v66, v66, v74
    v_mul_f32 v67, v67, v75
    v_mul_f32 v68, v68, v76
    v_mul_f32 v69, v69, v77
    v_mul_f32 v70, v70, v78
    v_mul_f32 v71, v71, v79
    v_lshlrev_b32 v72, 16, v200
    v_and_b32 v73, 0xffff0000, v200
    v_lshlrev_b32 v74, 16, v201
    v_and_b32 v75, 0xffff0000, v201
    v_lshlrev_b32 v76, 16, v202
    v_and_b32 v77, 0xffff0000, v202
    v_lshlrev_b32 v78, 16, v203
    v_and_b32 v79, 0xffff0000, v203
    v_add_u32 v7, 45056, v7
    s_waitcnt lgkmcnt(0)
    s_barrier
    ds_read_b128 v[96:99], v7 offset:0
    ds_read_b128 v[100:103], v7 offset:9216
    ds_read_b128 v[104:107], v7 offset:18432
    ds_read_b128 v[108:111], v7 offset:27648
    s_waitcnt lgkmcnt(3)
    v_dot2_f32_bf16 v80, v96, s46, 0
    v_dot2_f32_bf16 v81, v96, s47, 0
    v_dot2_f32_bf16 v82, v97, s46, 0
    v_dot2_f32_bf16 v83, v97, s47, 0
    v_dot2_f32_bf16 v84, v98, s46, 0
    v_dot2_f32_bf16 v85, v98, s47, 0
    v_dot2_f32_bf16 v86, v99, s46, 0
    v_dot2_f32_bf16 v87, v99, s47, 0
    s_waitcnt lgkmcnt(2)
    v_dot2c_f32_bf16 v80, s46, v100
    v_dot2c_f32_bf16 v81, s47, v100
    v_dot2c_f32_bf16 v82, s46, v101
    v_dot2c_f32_bf16 v83, s47, v101
    v_dot2c_f32_bf16 v84, s46, v102
    v_dot2c_f32_bf16 v85, s47, v102
    v_dot2c_f32_bf16 v86, s46, v103
    v_dot2c_f32_bf16 v87, s47, v103
    s_waitcnt lgkmcnt(1)
    v_dot2c_f32_bf16 v80, s46, v104
    v_dot2c_f32_bf16 v81, s47, v104
    v_dot2c_f32_bf16 v82, s46, v105
    v_dot2c_f32_bf16 v83, s47, v105
    v_dot2c_f32_bf16 v84, s46, v106
    v_dot2c_f32_bf16 v85, s47, v106
    v_dot2c_f32_bf16 v86, s46, v107
    v_dot2c_f32_bf16 v87, s47, v107
    s_waitcnt lgkmcnt(0)
    v_dot2c_f32_bf16 v80, s46, v108
    v_dot2c_f32_bf16 v81, s47, v108
    v_dot2c_f32_bf16 v82, s46, v109
    v_dot2c_f32_bf16 v83, s47, v109
    v_dot2c_f32_bf16 v84, s46, v110
    v_dot2c_f32_bf16 v85, s47, v110
    v_dot2c_f32_bf16 v86, s46, v111
    v_dot2c_f32_bf16 v87, s47, v111
    v_pk_fma_f32 v[80:81], v[80:81], v[64:65], v[72:73]
    v_pk_fma_f32 v[82:83], v[82:83], v[66:67], v[74:75]
    v_pk_fma_f32 v[84:85], v[84:85], v[68:69], v[76:77]
    v_pk_fma_f32 v[86:87], v[86:87], v[70:71], v[78:79]
    v_cvt_pk_bf16_f32 v88, v80, v81
    v_cvt_pk_bf16_f32 v89, v82, v83
    v_cvt_pk_bf16_f32 v90, v84, v85
    v_cvt_pk_bf16_f32 v91, v86, v87
    buffer_store_dwordx4 v[88:91], v6, s[32:35], 0 offen sc0 sc1
    s_add_u32 s48, s2, s36
    s_cmp_lg_u32 s48, 0
    s_cbranch_scc1 L_ep_33
    s_mov_b64 exec, 1
    v_mov_b32 v62, s3
    s_mov_b32 s48, 15138816
    buffer_store_dword v62, off, s[20:23], s48 sc1
    s_mov_b64 exec, -1
L_ep_33:
    s_endpgm
L_slow_15:
    s_waitcnt vmcnt(0)
    s_lshl_b32 s48, s56, 16
    s_add_u32 s54, s48, 2097152
    s_add_u32 s55, s48, 4194304
    s_mov_b32 s50, 0
    v_and_b32 v3, 15, v1
    v_lshlrev_b32 v3, 4, v3
    v_lshrrev_b32 v7, 5, v1
    v_lshl_add_u32 v3, v7, 8, v3
    v_mov_b32 v7, 0xff7fffff
L_p1_34:
    s_add_u32 s48, s54, s50
    buffer_load_dwordx4 v[220:223], v2, s[20:23], s48 offen sc1
    s_waitcnt vmcnt(0)
    v_mfma_f32_32x32x16_bf16 v[32:47], v[220:223], v[228:231], 0
    s_nop 15
    v_max3_f32 v7, v7, v32, v33
    v_max3_f32 v7, v7, v34, v35
    v_max3_f32 v7, v7, v36, v37
    v_max3_f32 v7, v7, v38, v39
    v_max3_f32 v7, v7, v40, v41
    v_max3_f32 v7, v7, v42, v43
    v_max3_f32 v7, v7, v44, v45
    v_max3_f32 v7, v7, v46, v47
    s_add_u32 s50, s50, 1024
    s_cmp_lt_u32 s50, 0x10000
    s_cbranch_scc1 L_p1_34
    v_mov_b32 v64, v7
    s_nop 1
    v_permlane32_swap_b32 v7, v64
    s_nop 1
    v_max_f32 v7, v7, v64
    v_sub_f32 v64, 0, v7
    v_mov_b32 v80, 0
    v_sub_f32 v65, 0, v7
    v_mov_b32 v81, 0
    v_sub_f32 v66, 0, v7
    v_mov_b32 v82, 0
    v_sub_f32 v67, 0, v7
    v_mov_b32 v83, 0
    v_sub_f32 v68, 0, v7
    v_mov_b32 v84, 0
    v_sub_f32 v69, 0, v7
    v_mov_b32 v85, 0
    v_sub_f32 v70, 0, v7
    v_mov_b32 v86, 0
    v_sub_f32 v71, 0, v7
    v_mov_b32 v87, 0
    v_sub_f32 v72, 0, v7
    v_mov_b32 v88, 0
    v_sub_f32 v73, 0, v7
    v_mov_b32 v89, 0
    v_sub_f32 v74, 0, v7
    v_mov_b32 v90, 0
    v_sub_f32 v75, 0, v7
    v_mov_b32 v91, 0
    v_sub_f32 v76, 0, v7
    v_mov_b32 v92, 0
    v_sub_f32 v77, 0, v7
    v_mov_b32 v93, 0
    v_sub_f32 v78, 0, v7
    v_mov_b32 v94, 0
    v_sub_f32 v79, 0, v7
    v_mov_b32 v95, 0
    s_mov_b32 s50, 0
L_p2_35:
    s_add_u32 s48, s54, s50
    s_add_u32 s49, s55, s50
    buffer_load_dwordx4 v[220:223], v2, s[20:23], s48 offen sc1
    s_mov_b32 exec_lo, 0xffff
    s_mov_b32 exec_hi, 0xffff
    buffer_load_dwordx4 v[184:187], v3, s[20:23], s49 offen sc1
    buffer_load_dwordx4 v[188:191], v3, s[20:23], s49 offen offset:512 sc1
    s_mov_b64 exec, -1
    s_waitcnt vmcnt(0)
    v_mfma_f32_32x32x16_bf16 v[32:47], v[220:223], v[228:231], v[64:79]
    s_nop 15
    v_exp_f32 v32, v32
    v_exp_f32 v33, v33
    v_exp_f32 v34, v34
    v_exp_f32 v35, v35
    v_exp_f32 v36, v36
    v_exp_f32 v37, v37
    v_exp_f32 v38, v38
    v_exp_f32 v39, v39
    v_exp_f32 v40, v40
    v_exp_f32 v41, v41
    v_exp_f32 v42, v42
    v_exp_f32 v43, v43
    v_exp_f32 v44, v44
    v_exp_f32 v45, v45
    v_exp_f32 v46, v46
    v_exp_f32 v47, v47
    s_nop 1
    v_smfmac_f32_32x32x32_bf16 v[80:95], v[184:187], v[32:39], v4
    v_smfmac_f32_32x32x32_bf16 v[80:95], v[188:191], v[40:47], v4
    s_nop 15
    s_add_u32 s50, s50, 1024
    s_cmp_lt_u32 s50, 0x10000
    s_cbranch_scc1 L_p2_35
    s_branch L_fin_16
L_os_17:
    s_call_b64 s[4:5], L_ort_36
    s_branch L_ob_18
L_os_19:
    s_call_b64 s[4:5], L_ort_36
    s_branch L_ob_20
L_os_21:
    s_call_b64 s[4:5], L_ort_36
    s_branch L_ob_22
L_os_23:
    s_call_b64 s[4:5], L_ort_36
    s_branch L_ob_24
L_os_25:
    s_call_b64 s[4:5], L_ort_36
    s_branch L_ob_26
L_os_27:
    s_call_b64 s[4:5], L_ort_36
    s_branch L_ob_28
L_os_29:
    s_call_b64 s[4:5], L_ort_36
    s_branch L_ob_30
L_os_31:
    s_call_b64 s[4:5], L_ort_36
    s_branch L_ob_32
L_ort_36:
    s_mov_b32 s79, 20000
L_orl_37:
    buffer_load_dwordx4 v[128:131], v2, s[20:23], s53 offen offset:0 sc1
    buffer_load_dwordx4 v[132:135], v2, s[20:23], s53 offen offset:1024 sc1
    buffer_load_dwordx4 v[136:139], v2, s[20:23], s53 offen offset:2048 sc1
    buffer_load_dwordx4 v[140:143], v2, s[20:23], s53 offen offset:3072 sc1
    buffer_load_dwordx4 v[144:147], v2, s[20:23], s51 offen offset:0 sc1
    buffer_load_dwordx4 v[148:151], v2, s[20:23], s51 offen offset:1024 sc1
    buffer_load_dwordx4 v[152:155], v2, s[20:23], s51 offen offset:2048 sc1
    buffer_load_dwordx4 v[156:159], v2, s[20:23], s51 offen offset:3072 sc1
    s_sub_u32 s79, s79, 1
    s_waitcnt vmcnt(0)
    v_max_u32 v61, v128, v129
    v_max3_u32 v61, v61, v130, v131
    v_max3_u32 v61, v61, v132, v133
    v_max3_u32 v61, v61, v134, v135
    v_max3_u32 v61, v61, v136, v137
    v_max3_u32 v61, v61, v138, v139
    v_max3_u32 v61, v61, v140, v141
    v_max3_u32 v61, v61, v142, v143
    v_max3_u32 v61, v61, v144, v145
    v_max3_u32 v61, v61, v146, v147
    v_max3_u32 v61, v61, v148, v149
    v_max3_u32 v61, v61, v150, v151
    v_max3_u32 v61, v61, v152, v153
    v_max3_u32 v61, v61, v154, v155
    v_max3_u32 v61, v61, v156, v157
    v_max3_u32 v61, v61, v158, v159
    v_cmp_eq_u32 vcc, -1, v61
    s_cmp_eq_u32 s79, 0
    s_cbranch_scc1 L_ord_38
    s_cbranch_vccnz L_orl_37
L_ord_38:
    s_setpc_b64 s[4:5]
L_end:
    s_endpgm
.section .rodata,"a"
.p2align 6
.amdhsa_kernel recurrent_scan__mha_block__swiglu_ffn__prompt_kernel
  .amdhsa_next_free_vgpr 256
  .amdhsa_next_free_sgpr 102
  .amdhsa_accum_offset 256
  .amdhsa_group_segment_fixed_size 0
  .amdhsa_kernarg_size 80
  .amdhsa_user_sgpr_count 2
  .amdhsa_user_sgpr_kernarg_segment_ptr 1
  .amdhsa_system_sgpr_workgroup_id_x 1
.end_amdhsa_kernel
```
